```python
import torch

def _softmax(x, axis=-1):
    return torch.softmax(x, dim=axis)
def _gelu(x):
    return torch.nn.functional.gelu(x, approximate="tanh")
def _silu(x):
    return torch.nn.functional.silu(x)
def _sigmoid(x):
    return torch.sigmoid(x)
def _layernorm(x, axis=-1, eps=1e-5):
    m = x.mean(dim=axis, keepdim=True)
    v = x.var(dim=axis, keepdim=True, unbiased=False)
    return (x - m) / torch.sqrt(v + eps)
def _scatter_add(tgt, idx, src, axis=0):
    return tgt.clone().index_add_(axis, idx, src)
def _segment_sum(src, seg, n):
    out = torch.zeros((n,) + src.shape[1:], dtype=src.dtype)
    return out.index_add_(0, seg, src)
def _pad(x, pw):
    flat = tuple(v for pair in reversed(pw) for v in pair)
    return torch.nn.functional.pad(x, flat)

kernel_name = 'interleave_layers__sliding_block_cached__mixer_token_mlp__decode'

def setup_inputs():

    _w = (lambda a: (lambda t: t.to(torch.bfloat16) if t.is_floating_point() else t)(torch.as_tensor(a)))
    def _A_setup():
        B, Sq, D = 4, 1, 512
        Hq, Hkv, Sk, Dh = 32, 8, 16384, 128
        assert Hq % Hkv == 0, (Hq, Hkv)
        return {
            "x": _w((lambda *s: torch.randn(*s, dtype=torch.bfloat16) * 0.05)(B, Sq, D)),
            "k_cache": _w((lambda *s: torch.randn(*s, dtype=torch.bfloat16) * 0.8)(B, Hkv, Sk, Dh)),
            "v_cache": _w((lambda *s: torch.randn(*s, dtype=torch.bfloat16) * 1.6)(B, Hkv, Sk, Dh)),
            "wq": _w((lambda *s: torch.randn(*s, dtype=torch.bfloat16) * 0.8)(D, Hq * Dh) * (D ** -0.5)),
            "wo": _w((lambda *s: torch.randn(*s, dtype=torch.bfloat16) * 1.6)(Hq * Dh, D) * ((Hq * Dh) ** -0.5)),
        }
    _A_in = _A_setup()

    def _B_setup():
        B, S, D, F = 4, 1, 512, 1792
        return {
            "x": _w((lambda *s: torch.randn(*s, dtype=torch.bfloat16) * 0.05)(B, S, D)),
            "w1": _w((lambda *s: torch.randn(*s, dtype=torch.bfloat16) * 0.8)(S, F) * (S ** -0.5)),
            "b1": _w((lambda *s: torch.randn(*s, dtype=torch.bfloat16) * 0.2)(F) * 0.02),
            "w2": _w((lambda *s: torch.randn(*s, dtype=torch.bfloat16) * 0.2)(F, S) * (F ** -0.5)),
            "b2": _w((lambda *s: torch.randn(*s, dtype=torch.bfloat16) * 0.2)(S) * 0.02),
        }
    _B_in = _B_setup()

    return {
        "A_x": _A_in["x"],
        "A_k_cache": _A_in["k_cache"],
        "A_v_cache": _A_in["v_cache"],
        "A_wq": _A_in["wq"],
        "A_wo": _A_in["wo"],
        "B_x": _B_in["x"],
        "B_w1": _B_in["w1"],
        "B_b1": _B_in["b1"],
        "B_w2": _B_in["w2"],
        "B_b2": _B_in["b2"],
    }

def reference(A_x, A_k_cache, A_v_cache, A_wq, A_wo, B_x, B_w1, B_b1, B_w2, B_b2):
    def _A_ref(x, k_cache, v_cache, wq, wo):
        B, Sq, D = x.shape
        Hq, Dh = 32, 128
        Hkv, Sk = k_cache.shape[1], k_cache.shape[2]
        W = min(4096, max(256, Sk // 4))
        rep = Hq // Hkv
        q = (lambda x, *d: x.permute(*d))((x @ wq).reshape(B, Sq, Hq, Dh), 0, 2, 1, 3)
        k = (lambda x, n, axis: torch.repeat_interleave(x, n, dim=axis))(k_cache[:, :, Sk - W:, :], rep, axis=1)
        v = (lambda x, n, axis: torch.repeat_interleave(x, n, dim=axis))(v_cache[:, :, Sk - W:, :], rep, axis=1)
        scores = torch.einsum("bhqd,bhkd->bhqk", q, k) * (Dh ** -0.5)
        p = _softmax(scores, axis=-1)
        o = torch.einsum("bhqk,bhkd->bhqd", p, v)
        return (lambda x, *d: x.permute(*d))(o, 0, 2, 1, 3).reshape(B, Sq, Hq * Dh) @ wo

    def _B_ref(x, w1, b1, w2, b2):
        B, S, D = x.shape
        h = _layernorm(x, axis=-1)
        u = torch.einsum("bsd,sf->bdf", h, w1) + b1
        u = _gelu(u)
        y = torch.einsum("bdf,fs->bds", u, w2) + b2
        return (lambda x, *d: x.permute(*d))(y, 0, 2, 1)

    x = A_x
    x = x + _A_ref(_layernorm(x, axis=-1), A_k_cache, A_v_cache, A_wq, A_wo)
    x = x + _B_ref(_layernorm(x, axis=-1), B_w1, B_b1, B_w2, B_b2)
    x = x + _A_ref(_layernorm(x, axis=-1), A_k_cache, A_v_cache, A_wq, A_wo)
    x = x + _B_ref(_layernorm(x, axis=-1), B_w1, B_b1, B_w2, B_b2)
    return x
```

```asm
; @launch grid=(256,1,1) block=(512,1,1) lds=99328
.amdgcn_target "amdgcn-amd-amdhsa--gfx950"
.text
.globl interleave_layers__sliding_block_cached__mixer_token_mlp__decode_kernel
.p2align 8
.type interleave_layers__sliding_block_cached__mixer_token_mlp__decode_kernel,@function
interleave_layers__sliding_block_cached__mixer_token_mlp__decode_kernel:
  s_cmp_ge_u32 s2, 256
  s_cbranch_scc1 L_exit
  s_load_dwordx16 s[4:19], s[0:1], 0
  s_load_dwordx8 s[20:27], s[0:1], 64
  s_load_dwordx2 s[28:29], s[0:1], 96
  s_and_b32 s30, s2, 7
  s_lshr_b32 s34, s2, 3
  s_and_b32 s31, s34, 7
  s_lshr_b32 s32, s34, 3
  v_lshrrev_b32 v18, 6, v0
  v_mov_b32 v21, v0
  v_readfirstlane_b32 s33, v18
  v_and_b32 v20, 63, v0
  v_lshlrev_b32 v3, 2, v20
  v_lshlrev_b32 v12, 4, v20
  v_mov_b32 v24, -1
  v_mov_b32 v25, -1
  v_mov_b32 v26, -1
  v_mov_b32 v27, -1
  s_lshl_b32 s3, s32, 3
  s_add_u32 s3, s3, s30
  s_mul_i32 s35, s2, 3072
  s_add_u32 s35, s35, 0x8000
  s_lshl_b32 s56, s3, 10
  s_and_b32 s57, s31, 1
  s_lshl_b32 s57, s57, 7
  s_add_u32 s57, s57, s56
  s_lshr_b32 s58, s31, 1
  s_lshl_b32 s58, s58, 4
  s_add_u32 s57, s57, s58
  s_mov_b32 s68, 0x55555555
  s_mov_b32 s69, 0x55555555
  v_and_b32 v16, 3, v20
  v_lshlrev_b32 v16, 10, v16
  v_and_b32 v18, 4, v20
  v_lshl_add_u32 v16, v18, 6, v16
  v_and_b32 v18, 8, v20
  v_lshl_add_u32 v16, v18, 3, v16
  v_and_b32 v19, 48, v20
  v_add_u32 v16, v16, v19
  v_and_b32 v4, 7, v20
  v_lshrrev_b32 v14, 3, v20
  v_lshlrev_b32 v14, 16, v14
  v_lshl_add_u32 v14, v4, 4, v14
  v_and_b32 v2, 24, v20
  v_lshlrev_b32 v2, 5, v2
  v_and_b32 v18, 39, v20
  v_lshl_add_u32 v2, v18, 1, v2
  v_lshlrev_b32 v4, 3, v4
  v_and_b32 v22, 15, v20
  v_lshlrev_b32 v28, 3, v19
  v_lshl_add_u32 v28, v22, 2, v28
  v_cmp_gt_u32 vcc, 48, v20
  v_add_u32 v29, 64, v28
  s_nop 0
  v_cndmask_b32 v29, v28, v29, vcc
  v_lshlrev_b32 v30, 1, v21
  v_min_u32 v23, 6, v22
  v_lshl_add_u32 v23, v23, 6, v19
  s_lshl_b32 s60, s3, 22
  s_add_u32 s60, s60, 0x300000
  s_lshl_b32 s61, s31, 17
  s_add_u32 s60, s60, s61
  s_lshl_b32 s61, s33, 12
  s_add_u32 s60, s60, s61
  s_add_u32 s52, s34, 0
  s_and_b32 s52, s52, 3
  s_lshl_b32 s52, s52, 15
  s_add_u32 s53, s34, 1
  s_and_b32 s53, s53, 3
  s_lshl_b32 s53, s53, 15
  s_add_u32 s54, s34, 2
  s_and_b32 s54, s54, 3
  s_lshl_b32 s54, s54, 15
  s_add_u32 s55, s34, 3
  s_and_b32 s55, s55, 3
  s_lshl_b32 s55, s55, 15
  s_lshl_b32 s62, s33, 19
  s_lshl_b32 s61, s30, 10
  s_add_u32 s62, s62, s61
  s_lshl_b32 s61, s31, 7
  s_add_u32 s62, s62, s61
  s_mul_i32 s63, s33, 448
  s_lshl_b32 s64, s32, 10
  v_mov_b32 v0, 0
  v_mov_b32 v1, 0
  s_waitcnt lgkmcnt(0)
  s_add_u32 s38, s28, s57
  s_addc_u32 s39, s29, 0
  s_add_u32 s6, s6, s60
  s_addc_u32 s7, s7, 0
  s_add_u32 s10, s10, s62
  s_addc_u32 s11, s11, 0
  s_add_u32 s8, s8, s60
  s_addc_u32 s9, s9, 0
  s_add_u32 s14, s6, s52
  s_addc_u32 s15, s7, 0
  global_load_dwordx4 v[88:91], v16, s[14:15] offset:0 nt
  global_load_dwordx4 v[92:95], v16, s[14:15] offset:512 nt
  global_load_dwordx4 v[96:99], v16, s[14:15] offset:128 nt
  global_load_dwordx4 v[100:103], v16, s[14:15] offset:640 nt
  s_cmp_lg_u32 s33, 0
  s_cbranch_scc1 L_cl1
  s_add_u32 s66, s28, s35
  s_addc_u32 s67, s29, 0
  global_store_dwordx4 v12, v[24:27], s[66:67] offset:0 sc1
  global_store_dwordx4 v12, v[24:27], s[66:67] offset:1024 sc1
  global_store_dwordx4 v12, v[24:27], s[66:67] offset:2048 sc1
  s_mov_b64 exec, s[68:69]
  global_store_dword v2, v24, s[38:39] sc1
  s_mov_b64 exec, -1
L_cl1:
  s_add_u32 s66, s16, s63
  s_addc_u32 s67, s17, 0
  s_add_u32 s72, s18, s63
  s_addc_u32 s73, s19, 0
  s_add_u32 s70, s20, s63
  s_addc_u32 s71, s21, 0
  s_add_u32 s4, s4, s64
  s_addc_u32 s5, s5, 0
  global_load_dword v32, v28, s[66:67]
  global_load_dword v34, v28, s[72:73]
  global_load_dwordx4 v[244:247], v23, s[70:71]
  global_load_short_d16_hi v0, v30, s[4:5]
  global_load_dword v33, v29, s[66:67]
  global_load_dword v35, v29, s[72:73]
  s_barrier
  s_add_u32 s36, s28, s56
  s_addc_u32 s37, s29, 0
  s_lshl_b32 s56, s3, 3
  s_add_u32 s56, s56, s33
  s_mul_i32 s57, s56, 1152
  s_add_u32 s57, s57, 98304
  s_add_u32 s40, s28, s57
  s_addc_u32 s41, s29, 0
  s_lshl_b32 s57, s31, 5
  s_add_u32 s42, s40, s57
  s_addc_u32 s43, s41, 0
  s_lshl_b32 s57, s31, 3
  s_add_u32 s44, s40, s57
  s_addc_u32 s45, s41, 0
  s_lshl_b32 s56, s32, 14
  s_add_u32 s56, s56, 32768
  s_lshl_b32 s57, s33, 11
  s_add_u32 s57, s57, s56
  s_add_u32 s46, s28, s57
  s_addc_u32 s47, s29, 0
  s_xor_b32 s35, s31, 4
  s_lshl_b32 s57, s35, 11
  s_add_u32 s57, s57, s56
  s_lshl_b32 s56, s30, 8
  s_add_u32 s57, s57, s56
  s_add_u32 s48, s28, s57
  s_addc_u32 s49, s29, 0
  s_lshl_b32 s56, s30, 19
  s_lshr_b32 s57, s33, 1
  s_lshl_b32 s57, s57, 17
  s_add_u32 s56, s56, s57
  s_and_b32 s57, s33, 1
  s_lshl_b32 s57, s57, 12
  s_add_u32 s56, s56, s57
  s_lshl_b32 s57, s35, 7
  s_add_u32 s56, s56, s57
  s_add_u32 s12, s12, s56
  s_addc_u32 s13, s13, 0
  s_add_u32 s24, s24, s64
  s_addc_u32 s25, s25, 0
  s_mov_b32 s56, 0x8000
  s_mov_b32 s57, 0
  s_mov_b32 s50, 0
  s_mov_b32 s59, 0x3e0293ee
  s_mov_b32 s62, 0x3b000000
  s_mov_b32 s63, 0x3b000000
  s_mov_b32 s70, 0x05040100
  s_mov_b32 s71, 0x07060302
  s_mov_b32 s72, 0xc0135761
  s_mov_b32 s74, 0xbdd2d3e8
  s_mov_b32 s75, 0xbdd2d3e8
  s_getreg_b32 s51, hwreg(HW_REG_XCC_ID, 0, 3)
  s_lshl_b32 s51, s51, 3
  v_and_b32 v18, 3, v20
  v_mul_u32_u24 v5, 2064, v18
  v_and_b32 v36, 12, v20
  v_lshl_add_u32 v5, v36, 4, v5
  v_add_u32 v5, v5, v19
  s_lshl_b32 s35, s33, 8
  v_add_u32 v5, s35, v5
  s_lshl_b32 s4, s33, 3
  v_mov_b32 v13, s4
  s_add_u32 s4, s4, 16640
  v_lshl_add_u32 v7, v18, 6, s4
  s_lshr_b32 s4, s33, 1
  s_and_b32 s5, s33, 1
  s_lshl_b32 s5, s5, 2
  s_add_u32 s5, s5, s4
  s_mul_i32 s5, s5, 2064
  v_add_u32 v6, s5, v3
  s_lshl_b32 s4, s4, 6
  s_add_u32 s4, s4, 16640
  v_add_u32 v8, s4, v4
  s_lshl_b32 s4, s33, 7
  s_add_u32 s4, s4, 17664
  v_lshl_add_u32 v9, v20, 1, s4
  v_and_b32 v36, 1, v20
  v_lshl_add_u32 v10, v19, 1, s4
  v_lshl_add_u32 v10, v36, 4, v10
  s_add_u32 s35, s35, 18688
  v_lshl_add_u32 v11, v4, 2, s35
  v_and_b32 v36, 8, v20
  v_lshl_add_u32 v11, v36, 1, v11
  v_lshrrev_b32 v36, 2, v19
  v_add_u32 v11, v11, v36
  s_and_b32 s4, s2, 127
  s_lshl_b32 s4, s4, 5
  s_lshr_b32 s5, s2, 7
  s_lshl_b32 s5, s5, 15
  s_add_u32 s4, s4, s5
  s_add_u32 s4, s4, 1065366016
  v_add_u32 v17, s4, v22
  global_load_dwordx4 v[64:67], v14, s[10:11] nt
  v_add_u32 v14, 0x2000, v14
  global_load_dwordx4 v[68:71], v14, s[10:11] nt
  v_add_u32 v14, 0x2000, v14
  global_load_dwordx4 v[72:75], v14, s[10:11] nt
  v_add_u32 v14, 0x2000, v14
  global_load_dwordx4 v[76:79], v14, s[10:11] nt
  v_add_u32 v14, 0x2000, v14
  s_waitcnt vmcnt(4)
  s_cmp_lg_u32 s33, 0
  s_cbranch_scc1 L_fl2
  s_lshl_b32 s4, s3, 3
  v_mov_b32 v20, s4
  s_lshl_b64 s[4:5], 1, s51
  v_mov_b32 v18, s4
  v_mov_b32 v19, s5
  s_mov_b64 exec, 1
  global_atomic_add_x2 v20, v[18:19], s[26:27] sc1
  s_mov_b64 exec, -1
L_fl2:
  v_perm_b32 v252, v34, v32, s70
  v_perm_b32 v253, v34, v32, s71
  v_perm_b32 v254, v35, v33, s70
  v_perm_b32 v255, v35, v33, s71
  v_mov_b32 v52, s72
  v_mov_b32 v53, s72
  s_mov_b32 s60, 65535
  s_mov_b32 s61, 0
  v_add_u32 v18, 16, v17
  v_mov_b32_dpp v248, v244 row_newbcast:0 row_mask:0xf bank_mask:0xf
  v_mov_b32_dpp v249, v245 row_newbcast:0 row_mask:0xf bank_mask:0xf
  v_mov_b32_dpp v250, v246 row_newbcast:0 row_mask:0xf bank_mask:0xf
  v_mov_b32_dpp v251, v247 row_newbcast:0 row_mask:0xf bank_mask:0xf
  v_cndmask_b32 v36, v1, v17, s[60:61]
  v_mov_b32 v37, 0
  v_mov_b32 v38, 0
  v_cndmask_b32 v39, v1, v17, s[60:61]
  v_cndmask_b32 v40, v1, v18, s[60:61]
  v_mov_b32 v41, 0
  v_mov_b32 v42, 0
  v_cndmask_b32 v43, v1, v18, s[60:61]
  v_mfma_f32_16x16x16_bf16 v[20:23], v[252:253], v[36:37], 0
  v_mfma_f32_16x16x16_bf16 v[24:27], v[252:253], v[38:39], 0
  v_mfma_f32_16x16x16_bf16 v[28:31], v[252:253], v[40:41], 0
  v_mfma_f32_16x16x16_bf16 v[32:35], v[252:253], v[42:43], 0
  s_nop 4
  v_pk_mul_f32 v[36:37], v[20:21], v[20:21]
  v_pk_mul_f32 v[38:39], v[22:23], v[22:23]
  v_pk_mul_f32 v[40:41], v[24:25], v[24:25]
  v_pk_mul_f32 v[42:43], v[26:27], v[26:27]
  v_pk_fma_f32 v[36:37], v[36:37], s[74:75], v[52:53]
  v_pk_fma_f32 v[38:39], v[38:39], s[74:75], v[52:53]
  v_pk_fma_f32 v[40:41], v[40:41], s[74:75], v[52:53]
  v_pk_fma_f32 v[42:43], v[42:43], s[74:75], v[52:53]
  v_pk_mul_f32 v[36:37], v[36:37], v[20:21]
  v_pk_mul_f32 v[38:39], v[38:39], v[22:23]
  v_pk_mul_f32 v[40:41], v[40:41], v[24:25]
  v_pk_mul_f32 v[42:43], v[42:43], v[26:27]
  v_exp_f32 v36, v36
  v_exp_f32 v37, v37
  v_exp_f32 v38, v38
  v_exp_f32 v39, v39
  v_exp_f32 v40, v40
  v_exp_f32 v41, v41
  v_exp_f32 v42, v42
  v_exp_f32 v43, v43
  v_pk_add_f32 v[36:37], v[36:37], 1.0 op_sel_hi:[1,0]
  v_pk_add_f32 v[38:39], v[38:39], 1.0 op_sel_hi:[1,0]
  v_pk_add_f32 v[40:41], v[40:41], 1.0 op_sel_hi:[1,0]
  v_pk_add_f32 v[42:43], v[42:43], 1.0 op_sel_hi:[1,0]
  v_rcp_f32 v36, v36
  v_rcp_f32 v37, v37
  v_rcp_f32 v38, v38
  v_rcp_f32 v39, v39
  v_rcp_f32 v40, v40
  v_rcp_f32 v41, v41
  v_rcp_f32 v42, v42
  v_rcp_f32 v43, v43
  v_pk_mul_f32 v[36:37], v[36:37], v[20:21]
  v_pk_mul_f32 v[38:39], v[38:39], v[22:23]
  v_pk_mul_f32 v[40:41], v[40:41], v[24:25]
  v_pk_mul_f32 v[42:43], v[42:43], v[26:27]
  v_cvt_pk_bf16_f32 v44, v36, v40
  v_cvt_pk_bf16_f32 v45, v37, v41
  v_cvt_pk_bf16_f32 v46, v38, v42
  v_cvt_pk_bf16_f32 v47, v39, v43
  s_nop 1
  v_mfma_f32_16x16x32_bf16 v[152:155], v[248:251], v[44:47], 0
  global_load_dwordx4 v[80:83], v14, s[10:11] nt
  v_add_u32 v14, 0x2000, v14
  s_add_u32 s14, s6, s53
  s_addc_u32 s15, s7, 0
  global_load_dwordx4 v[104:107], v16, s[14:15] offset:0 nt
  v_pk_mul_f32 v[36:37], v[28:29], v[28:29]
  v_pk_mul_f32 v[38:39], v[30:31], v[30:31]
  v_pk_mul_f32 v[40:41], v[32:33], v[32:33]
  v_pk_mul_f32 v[42:43], v[34:35], v[34:35]
  v_pk_fma_f32 v[36:37], v[36:37], s[74:75], v[52:53]
  v_pk_fma_f32 v[38:39], v[38:39], s[74:75], v[52:53]
  v_pk_fma_f32 v[40:41], v[40:41], s[74:75], v[52:53]
  v_pk_fma_f32 v[42:43], v[42:43], s[74:75], v[52:53]
  v_pk_mul_f32 v[36:37], v[36:37], v[28:29]
  v_pk_mul_f32 v[38:39], v[38:39], v[30:31]
  v_pk_mul_f32 v[40:41], v[40:41], v[32:33]
  v_pk_mul_f32 v[42:43], v[42:43], v[34:35]
  v_exp_f32 v36, v36
  v_exp_f32 v37, v37
  v_exp_f32 v38, v38
  v_exp_f32 v39, v39
  v_exp_f32 v40, v40
  v_exp_f32 v41, v41
  v_exp_f32 v42, v42
  v_exp_f32 v43, v43
  v_pk_add_f32 v[36:37], v[36:37], 1.0 op_sel_hi:[1,0]
  v_pk_add_f32 v[38:39], v[38:39], 1.0 op_sel_hi:[1,0]
  v_pk_add_f32 v[40:41], v[40:41], 1.0 op_sel_hi:[1,0]
  v_pk_add_f32 v[42:43], v[42:43], 1.0 op_sel_hi:[1,0]
  v_rcp_f32 v36, v36
  v_rcp_f32 v37, v37
  v_rcp_f32 v38, v38
  v_rcp_f32 v39, v39
  v_rcp_f32 v40, v40
  v_rcp_f32 v41, v41
  v_rcp_f32 v42, v42
  v_rcp_f32 v43, v43
  v_pk_mul_f32 v[36:37], v[36:37], v[28:29]
  v_pk_mul_f32 v[38:39], v[38:39], v[30:31]
  v_pk_mul_f32 v[40:41], v[40:41], v[32:33]
  v_pk_mul_f32 v[42:43], v[42:43], v[34:35]
  v_cvt_pk_bf16_f32 v48, v36, v40
  v_cvt_pk_bf16_f32 v49, v37, v41
  v_cvt_pk_bf16_f32 v50, v38, v42
  v_cvt_pk_bf16_f32 v51, v39, v43
  s_nop 1
  v_mfma_f32_16x16x32_bf16 v[156:159], v[248:251], v[48:51], 0
  s_barrier
  global_load_dwordx4 v[84:87], v14, s[10:11] nt
  v_add_u32 v14, 0x2000, v14
  global_load_dwordx4 v[108:111], v16, s[14:15] offset:512 nt
  s_mov_b32 s60, 65535
  s_mov_b32 s61, 0
  v_add_u32 v18, 16, v17
  v_mov_b32_dpp v248, v244 row_newbcast:1 row_mask:0xf bank_mask:0xf
  v_mov_b32_dpp v249, v245 row_newbcast:1 row_mask:0xf bank_mask:0xf
  v_mov_b32_dpp v250, v246 row_newbcast:1 row_mask:0xf bank_mask:0xf
  v_mov_b32_dpp v251, v247 row_newbcast:1 row_mask:0xf bank_mask:0xf
  v_cndmask_b32 v36, v1, v17, s[60:61]
  v_mov_b32 v37, 0
  v_mov_b32 v38, 0
  v_cndmask_b32 v39, v1, v17, s[60:61]
  v_cndmask_b32 v40, v1, v18, s[60:61]
  v_mov_b32 v41, 0
  v_mov_b32 v42, 0
  v_cndmask_b32 v43, v1, v18, s[60:61]
  v_mfma_f32_16x16x16_bf16 v[20:23], v[254:255], v[36:37], 0
  v_mfma_f32_16x16x16_bf16 v[24:27], v[254:255], v[38:39], 0
  v_mfma_f32_16x16x16_bf16 v[28:31], v[254:255], v[40:41], 0
  v_mfma_f32_16x16x16_bf16 v[32:35], v[254:255], v[42:43], 0
  s_nop 4
  v_pk_mul_f32 v[36:37], v[20:21], v[20:21]
  v_pk_mul_f32 v[38:39], v[22:23], v[22:23]
  v_pk_mul_f32 v[40:41], v[24:25], v[24:25]
  v_pk_mul_f32 v[42:43], v[26:27], v[26:27]
  v_pk_fma_f32 v[36:37], v[36:37], s[74:75], v[52:53]
  v_pk_fma_f32 v[38:39], v[38:39], s[74:75], v[52:53]
  v_pk_fma_f32 v[40:41], v[40:41], s[74:75], v[52:53]
  v_pk_fma_f32 v[42:43], v[42:43], s[74:75], v[52:53]
  v_pk_mul_f32 v[36:37], v[36:37], v[20:21]
  v_pk_mul_f32 v[38:39], v[38:39], v[22:23]
  v_pk_mul_f32 v[40:41], v[40:41], v[24:25]
  v_pk_mul_f32 v[42:43], v[42:43], v[26:27]
  v_exp_f32 v36, v36
  v_exp_f32 v37, v37
  v_exp_f32 v38, v38
  v_exp_f32 v39, v39
  v_exp_f32 v40, v40
  v_exp_f32 v41, v41
  v_exp_f32 v42, v42
  v_exp_f32 v43, v43
  v_pk_add_f32 v[36:37], v[36:37], 1.0 op_sel_hi:[1,0]
  v_pk_add_f32 v[38:39], v[38:39], 1.0 op_sel_hi:[1,0]
  v_pk_add_f32 v[40:41], v[40:41], 1.0 op_sel_hi:[1,0]
  v_pk_add_f32 v[42:43], v[42:43], 1.0 op_sel_hi:[1,0]
  v_rcp_f32 v36, v36
  v_rcp_f32 v37, v37
  v_rcp_f32 v38, v38
  v_rcp_f32 v39, v39
  v_rcp_f32 v40, v40
  v_rcp_f32 v41, v41
  v_rcp_f32 v42, v42
  v_rcp_f32 v43, v43
  v_pk_mul_f32 v[36:37], v[36:37], v[20:21]
  v_pk_mul_f32 v[38:39], v[38:39], v[22:23]
  v_pk_mul_f32 v[40:41], v[40:41], v[24:25]
  v_pk_mul_f32 v[42:43], v[42:43], v[26:27]
  v_cvt_pk_bf16_f32 v44, v36, v40
  v_cvt_pk_bf16_f32 v45, v37, v41
  v_cvt_pk_bf16_f32 v46, v38, v42
  v_cvt_pk_bf16_f32 v47, v39, v43
  s_nop 1
  v_mfma_f32_16x16x32_bf16 v[152:155], v[248:251], v[44:47], v[152:155]
  global_load_dwordx4 v[224:227], v14, s[10:11] nt
  v_add_u32 v14, 0x2000, v14
  global_load_dwordx4 v[112:115], v16, s[14:15] offset:128 nt
  v_pk_mul_f32 v[36:37], v[28:29], v[28:29]
  v_pk_mul_f32 v[38:39], v[30:31], v[30:31]
  v_pk_mul_f32 v[40:41], v[32:33], v[32:33]
  v_pk_mul_f32 v[42:43], v[34:35], v[34:35]
  v_pk_fma_f32 v[36:37], v[36:37], s[74:75], v[52:53]
  v_pk_fma_f32 v[38:39], v[38:39], s[74:75], v[52:53]
  v_pk_fma_f32 v[40:41], v[40:41], s[74:75], v[52:53]
  v_pk_fma_f32 v[42:43], v[42:43], s[74:75], v[52:53]
  v_pk_mul_f32 v[36:37], v[36:37], v[28:29]
  v_pk_mul_f32 v[38:39], v[38:39], v[30:31]
  v_pk_mul_f32 v[40:41], v[40:41], v[32:33]
  v_pk_mul_f32 v[42:43], v[42:43], v[34:35]
  v_exp_f32 v36, v36
  v_exp_f32 v37, v37
  v_exp_f32 v38, v38
  v_exp_f32 v39, v39
  v_exp_f32 v40, v40
  v_exp_f32 v41, v41
  v_exp_f32 v42, v42
  v_exp_f32 v43, v43
  v_pk_add_f32 v[36:37], v[36:37], 1.0 op_sel_hi:[1,0]
  v_pk_add_f32 v[38:39], v[38:39], 1.0 op_sel_hi:[1,0]
  v_pk_add_f32 v[40:41], v[40:41], 1.0 op_sel_hi:[1,0]
  v_pk_add_f32 v[42:43], v[42:43], 1.0 op_sel_hi:[1,0]
  v_rcp_f32 v36, v36
  v_rcp_f32 v37, v37
  v_rcp_f32 v38, v38
  v_rcp_f32 v39, v39
  v_rcp_f32 v40, v40
  v_rcp_f32 v41, v41
  v_rcp_f32 v42, v42
  v_rcp_f32 v43, v43
  v_pk_mul_f32 v[36:37], v[36:37], v[28:29]
  v_pk_mul_f32 v[38:39], v[38:39], v[30:31]
  v_pk_mul_f32 v[40:41], v[40:41], v[32:33]
  v_pk_mul_f32 v[42:43], v[42:43], v[34:35]
  v_cvt_pk_bf16_f32 v48, v36, v40
  v_cvt_pk_bf16_f32 v49, v37, v41
  v_cvt_pk_bf16_f32 v50, v38, v42
  v_cvt_pk_bf16_f32 v51, v39, v43
  s_nop 1
  v_mfma_f32_16x16x32_bf16 v[156:159], v[248:251], v[48:51], v[156:159]
  s_barrier
  global_load_dwordx4 v[228:231], v14, s[10:11] nt
  global_load_dwordx4 v[116:119], v16, s[14:15] offset:640 nt
  s_mov_b32 s60, 4294901760
  s_mov_b32 s61, 0
  v_add_u32 v18, 16, v17
  v_mov_b32_dpp v248, v244 row_newbcast:2 row_mask:0xf bank_mask:0xf
  v_mov_b32_dpp v249, v245 row_newbcast:2 row_mask:0xf bank_mask:0xf
  v_mov_b32_dpp v250, v246 row_newbcast:2 row_mask:0xf bank_mask:0xf
  v_mov_b32_dpp v251, v247 row_newbcast:2 row_mask:0xf bank_mask:0xf
  v_cndmask_b32 v36, v1, v17, s[60:61]
  v_mov_b32 v37, 0
  v_mov_b32 v38, 0
  v_cndmask_b32 v39, v1, v17, s[60:61]
  v_cndmask_b32 v40, v1, v18, s[60:61]
  v_mov_b32 v41, 0
  v_mov_b32 v42, 0
  v_cndmask_b32 v43, v1, v18, s[60:61]
  v_mfma_f32_16x16x16_bf16 v[20:23], v[252:253], v[36:37], 0
  v_mfma_f32_16x16x16_bf16 v[24:27], v[252:253], v[38:39], 0
  v_mfma_f32_16x16x16_bf16 v[28:31], v[252:253], v[40:41], 0
  v_mfma_f32_16x16x16_bf16 v[32:35], v[252:253], v[42:43], 0
  s_nop 4
  v_pk_mul_f32 v[36:37], v[20:21], v[20:21]
  v_pk_mul_f32 v[38:39], v[22:23], v[22:23]
  v_pk_mul_f32 v[40:41], v[24:25], v[24:25]
  v_pk_mul_f32 v[42:43], v[26:27], v[26:27]
  v_pk_fma_f32 v[36:37], v[36:37], s[74:75], v[52:53]
  v_pk_fma_f32 v[38:39], v[38:39], s[74:75], v[52:53]
  v_pk_fma_f32 v[40:41], v[40:41], s[74:75], v[52:53]
  v_pk_fma_f32 v[42:43], v[42:43], s[74:75], v[52:53]
  v_pk_mul_f32 v[36:37], v[36:37], v[20:21]
  v_pk_mul_f32 v[38:39], v[38:39], v[22:23]
  v_pk_mul_f32 v[40:41], v[40:41], v[24:25]
  v_pk_mul_f32 v[42:43], v[42:43], v[26:27]
  v_exp_f32 v36, v36
  v_exp_f32 v37, v37
  v_exp_f32 v38, v38
  v_exp_f32 v39, v39
  v_exp_f32 v40, v40
  v_exp_f32 v41, v41
  v_exp_f32 v42, v42
  v_exp_f32 v43, v43
  v_pk_add_f32 v[36:37], v[36:37], 1.0 op_sel_hi:[1,0]
  v_pk_add_f32 v[38:39], v[38:39], 1.0 op_sel_hi:[1,0]
  v_pk_add_f32 v[40:41], v[40:41], 1.0 op_sel_hi:[1,0]
  v_pk_add_f32 v[42:43], v[42:43], 1.0 op_sel_hi:[1,0]
  v_rcp_f32 v36, v36
  v_rcp_f32 v37, v37
  v_rcp_f32 v38, v38
  v_rcp_f32 v39, v39
  v_rcp_f32 v40, v40
  v_rcp_f32 v41, v41
  v_rcp_f32 v42, v42
  v_rcp_f32 v43, v43
  v_pk_mul_f32 v[36:37], v[36:37], v[20:21]
  v_pk_mul_f32 v[38:39], v[38:39], v[22:23]
  v_pk_mul_f32 v[40:41], v[40:41], v[24:25]
  v_pk_mul_f32 v[42:43], v[42:43], v[26:27]
  v_cvt_pk_bf16_f32 v44, v36, v40
  v_cvt_pk_bf16_f32 v45, v37, v41
  v_cvt_pk_bf16_f32 v46, v38, v42
  v_cvt_pk_bf16_f32 v47, v39, v43
  s_nop 1
  v_mfma_f32_16x16x32_bf16 v[152:155], v[248:251], v[44:47], v[152:155]
  s_add_u32 s14, s6, s54
  s_addc_u32 s15, s7, 0
  global_load_dwordx4 v[120:123], v16, s[14:15] offset:0 nt
  global_load_dwordx4 v[124:127], v16, s[14:15] offset:512 nt
  v_pk_mul_f32 v[36:37], v[28:29], v[28:29]
  v_pk_mul_f32 v[38:39], v[30:31], v[30:31]
  v_pk_mul_f32 v[40:41], v[32:33], v[32:33]
  v_pk_mul_f32 v[42:43], v[34:35], v[34:35]
  v_pk_fma_f32 v[36:37], v[36:37], s[74:75], v[52:53]
  v_pk_fma_f32 v[38:39], v[38:39], s[74:75], v[52:53]
  v_pk_fma_f32 v[40:41], v[40:41], s[74:75], v[52:53]
  v_pk_fma_f32 v[42:43], v[42:43], s[74:75], v[52:53]
  v_pk_mul_f32 v[36:37], v[36:37], v[28:29]
  v_pk_mul_f32 v[38:39], v[38:39], v[30:31]
  v_pk_mul_f32 v[40:41], v[40:41], v[32:33]
  v_pk_mul_f32 v[42:43], v[42:43], v[34:35]
  v_exp_f32 v36, v36
  v_exp_f32 v37, v37
  v_exp_f32 v38, v38
  v_exp_f32 v39, v39
  v_exp_f32 v40, v40
  v_exp_f32 v41, v41
  v_exp_f32 v42, v42
  v_exp_f32 v43, v43
  v_pk_add_f32 v[36:37], v[36:37], 1.0 op_sel_hi:[1,0]
  v_pk_add_f32 v[38:39], v[38:39], 1.0 op_sel_hi:[1,0]
  v_pk_add_f32 v[40:41], v[40:41], 1.0 op_sel_hi:[1,0]
  v_pk_add_f32 v[42:43], v[42:43], 1.0 op_sel_hi:[1,0]
  v_rcp_f32 v36, v36
  v_rcp_f32 v37, v37
  v_rcp_f32 v38, v38
  v_rcp_f32 v39, v39
  v_rcp_f32 v40, v40
  v_rcp_f32 v41, v41
  v_rcp_f32 v42, v42
  v_rcp_f32 v43, v43
  v_pk_mul_f32 v[36:37], v[36:37], v[28:29]
  v_pk_mul_f32 v[38:39], v[38:39], v[30:31]
  v_pk_mul_f32 v[40:41], v[40:41], v[32:33]
  v_pk_mul_f32 v[42:43], v[42:43], v[34:35]
  v_cvt_pk_bf16_f32 v48, v36, v40
  v_cvt_pk_bf16_f32 v49, v37, v41
  v_cvt_pk_bf16_f32 v50, v38, v42
  v_cvt_pk_bf16_f32 v51, v39, v43
  s_nop 1
  v_mfma_f32_16x16x32_bf16 v[156:159], v[248:251], v[48:51], v[156:159]
  s_barrier
  global_load_dwordx4 v[128:131], v16, s[14:15] offset:128 nt
  global_load_dwordx4 v[132:135], v16, s[14:15] offset:640 nt
  s_add_u32 s14, s6, s55
  s_addc_u32 s15, s7, 0
  global_load_dwordx4 v[136:139], v16, s[14:15] offset:0 nt
  global_load_dwordx4 v[140:143], v16, s[14:15] offset:512 nt
  s_waitcnt vmcnt(7)
  v_perm_b32 v56, v68, v64, s70
  v_perm_b32 v60, v68, v64, s71
  v_perm_b32 v57, v76, v72, s70
  v_perm_b32 v61, v76, v72, s71
  v_perm_b32 v64, v69, v65, s70
  v_perm_b32 v68, v69, v65, s71
  v_perm_b32 v72, v70, v66, s70
  v_perm_b32 v76, v70, v66, s71
  v_perm_b32 v65, v77, v73, s70
  v_perm_b32 v69, v77, v73, s71
  v_perm_b32 v73, v78, v74, s70
  v_perm_b32 v77, v78, v74, s71
  v_perm_b32 v58, v84, v80, s70
  v_perm_b32 v62, v84, v80, s71
  v_perm_b32 v80, v71, v67, s70
  v_perm_b32 v84, v71, v67, s71
  v_perm_b32 v66, v85, v81, s70
  v_perm_b32 v70, v85, v81, s71
  v_perm_b32 v81, v79, v75, s70
  v_perm_b32 v85, v79, v75, s71
  v_perm_b32 v74, v86, v82, s70
  v_perm_b32 v78, v86, v82, s71
  v_perm_b32 v82, v87, v83, s70
  v_perm_b32 v86, v87, v83, s71
  v_perm_b32 v59, v228, v224, s70
  v_perm_b32 v63, v228, v224, s71
  v_perm_b32 v67, v229, v225, s70
  v_perm_b32 v71, v229, v225, s71
  v_perm_b32 v75, v230, v226, s70
  v_perm_b32 v79, v230, v226, s71
  v_perm_b32 v83, v231, v227, s70
  v_perm_b32 v87, v231, v227, s71
  global_load_dwordx4 v[144:147], v16, s[14:15] offset:128 nt
  global_load_dwordx4 v[148:151], v16, s[14:15] offset:640 nt
  s_branch L_qp
L_qr:
  v_mov_b32 v52, s72
  v_mov_b32 v53, s72
  s_mov_b32 s60, 4294901760
  s_mov_b32 s61, 0
  v_add_u32 v18, 16, v17
  v_mov_b32_dpp v248, v244 row_newbcast:3 row_mask:0xf bank_mask:0xf
  v_mov_b32_dpp v249, v245 row_newbcast:3 row_mask:0xf bank_mask:0xf
  v_mov_b32_dpp v250, v246 row_newbcast:3 row_mask:0xf bank_mask:0xf
  v_mov_b32_dpp v251, v247 row_newbcast:3 row_mask:0xf bank_mask:0xf
  v_cndmask_b32 v36, v1, v17, s[60:61]
  v_mov_b32 v37, 0
  v_mov_b32 v38, 0
  v_cndmask_b32 v39, v1, v17, s[60:61]
  v_cndmask_b32 v40, v1, v18, s[60:61]
  v_mov_b32 v41, 0
  v_mov_b32 v42, 0
  v_cndmask_b32 v43, v1, v18, s[60:61]
  v_mfma_f32_16x16x16_bf16 v[20:23], v[254:255], v[36:37], 0
  v_mfma_f32_16x16x16_bf16 v[24:27], v[254:255], v[38:39], 0
  v_mfma_f32_16x16x16_bf16 v[28:31], v[254:255], v[40:41], 0
  v_mfma_f32_16x16x16_bf16 v[32:35], v[254:255], v[42:43], 0
  s_nop 4
  v_pk_mul_f32 v[36:37], v[20:21], v[20:21]
  v_pk_mul_f32 v[38:39], v[22:23], v[22:23]
  v_pk_mul_f32 v[40:41], v[24:25], v[24:25]
  v_pk_mul_f32 v[42:43], v[26:27], v[26:27]
  v_pk_fma_f32 v[36:37], v[36:37], s[74:75], v[52:53]
  v_pk_fma_f32 v[38:39], v[38:39], s[74:75], v[52:53]
  v_pk_fma_f32 v[40:41], v[40:41], s[74:75], v[52:53]
  v_pk_fma_f32 v[42:43], v[42:43], s[74:75], v[52:53]
  v_pk_mul_f32 v[36:37], v[36:37], v[20:21]
  v_pk_mul_f32 v[38:39], v[38:39], v[22:23]
  v_pk_mul_f32 v[40:41], v[40:41], v[24:25]
  v_pk_mul_f32 v[42:43], v[42:43], v[26:27]
  v_exp_f32 v36, v36
  v_exp_f32 v37, v37
  v_exp_f32 v38, v38
  v_exp_f32 v39, v39
  v_exp_f32 v40, v40
  v_exp_f32 v41, v41
  v_exp_f32 v42, v42
  v_exp_f32 v43, v43
  v_pk_add_f32 v[36:37], v[36:37], 1.0 op_sel_hi:[1,0]
  v_pk_add_f32 v[38:39], v[38:39], 1.0 op_sel_hi:[1,0]
  v_pk_add_f32 v[40:41], v[40:41], 1.0 op_sel_hi:[1,0]
  v_pk_add_f32 v[42:43], v[42:43], 1.0 op_sel_hi:[1,0]
  v_rcp_f32 v36, v36
  v_rcp_f32 v37, v37
  v_rcp_f32 v38, v38
  v_rcp_f32 v39, v39
  v_rcp_f32 v40, v40
  v_rcp_f32 v41, v41
  v_rcp_f32 v42, v42
  v_rcp_f32 v43, v43
  v_pk_mul_f32 v[36:37], v[36:37], v[20:21]
  v_pk_mul_f32 v[38:39], v[38:39], v[22:23]
  v_pk_mul_f32 v[40:41], v[40:41], v[24:25]
  v_pk_mul_f32 v[42:43], v[42:43], v[26:27]
  v_cvt_pk_bf16_f32 v44, v36, v40
  v_cvt_pk_bf16_f32 v45, v37, v41
  v_cvt_pk_bf16_f32 v46, v38, v42
  v_cvt_pk_bf16_f32 v47, v39, v43
  s_nop 1
  v_mfma_f32_16x16x32_bf16 v[152:155], v[248:251], v[44:47], v[152:155]
  v_mov_b32 v54, 0
  global_load_short_d16_hi v54, v1, s[22:23]
  global_load_dword v15, v3, s[26:27] sc1
  s_add_u32 s0, s8, s52
  s_addc_u32 s1, s9, 0
  global_load_dwordx4 v[160:163], v12, s[0:1] offset:0 nt
  v_pk_mul_f32 v[36:37], v[28:29], v[28:29]
  v_pk_mul_f32 v[38:39], v[30:31], v[30:31]
  v_pk_mul_f32 v[40:41], v[32:33], v[32:33]
  v_pk_mul_f32 v[42:43], v[34:35], v[34:35]
  v_pk_fma_f32 v[36:37], v[36:37], s[74:75], v[52:53]
  v_pk_fma_f32 v[38:39], v[38:39], s[74:75], v[52:53]
  v_pk_fma_f32 v[40:41], v[40:41], s[74:75], v[52:53]
  v_pk_fma_f32 v[42:43], v[42:43], s[74:75], v[52:53]
  v_pk_mul_f32 v[36:37], v[36:37], v[28:29]
  v_pk_mul_f32 v[38:39], v[38:39], v[30:31]
  v_pk_mul_f32 v[40:41], v[40:41], v[32:33]
  v_pk_mul_f32 v[42:43], v[42:43], v[34:35]
  v_exp_f32 v36, v36
  v_exp_f32 v37, v37
  v_exp_f32 v38, v38
  v_exp_f32 v39, v39
  v_exp_f32 v40, v40
  v_exp_f32 v41, v41
  v_exp_f32 v42, v42
  v_exp_f32 v43, v43
  v_pk_add_f32 v[36:37], v[36:37], 1.0 op_sel_hi:[1,0]
  v_pk_add_f32 v[38:39], v[38:39], 1.0 op_sel_hi:[1,0]
  v_pk_add_f32 v[40:41], v[40:41], 1.0 op_sel_hi:[1,0]
  v_pk_add_f32 v[42:43], v[42:43], 1.0 op_sel_hi:[1,0]
  v_rcp_f32 v36, v36
  v_rcp_f32 v37, v37
  v_rcp_f32 v38, v38
  v_rcp_f32 v39, v39
  v_rcp_f32 v40, v40
  v_rcp_f32 v41, v41
  v_rcp_f32 v42, v42
  v_rcp_f32 v43, v43
  v_pk_mul_f32 v[36:37], v[36:37], v[28:29]
  v_pk_mul_f32 v[38:39], v[38:39], v[30:31]
  v_pk_mul_f32 v[40:41], v[40:41], v[32:33]
  v_pk_mul_f32 v[42:43], v[42:43], v[34:35]
  v_cvt_pk_bf16_f32 v48, v36, v40
  v_cvt_pk_bf16_f32 v49, v37, v41
  v_cvt_pk_bf16_f32 v50, v38, v42
  v_cvt_pk_bf16_f32 v51, v39, v43
  s_nop 1
  v_mfma_f32_16x16x32_bf16 v[156:159], v[248:251], v[48:51], v[156:159]
  s_barrier
  global_load_dwordx4 v[164:167], v12, s[0:1] offset:1024 nt
  global_load_dwordx4 v[168:171], v12, s[0:1] offset:2048 nt
  s_mov_b32 s60, 0
  s_mov_b32 s61, 65535
  v_add_u32 v18, 16, v17
  v_mov_b32_dpp v248, v244 row_newbcast:4 row_mask:0xf bank_mask:0xf
  v_mov_b32_dpp v249, v245 row_newbcast:4 row_mask:0xf bank_mask:0xf
  v_mov_b32_dpp v250, v246 row_newbcast:4 row_mask:0xf bank_mask:0xf
  v_mov_b32_dpp v251, v247 row_newbcast:4 row_mask:0xf bank_mask:0xf
  v_cndmask_b32 v36, v1, v17, s[60:61]
  v_mov_b32 v37, 0
  v_mov_b32 v38, 0
  v_cndmask_b32 v39, v1, v17, s[60:61]
  v_cndmask_b32 v40, v1, v18, s[60:61]
  v_mov_b32 v41, 0
  v_mov_b32 v42, 0
  v_cndmask_b32 v43, v1, v18, s[60:61]
  v_mfma_f32_16x16x16_bf16 v[20:23], v[252:253], v[36:37], 0
  v_mfma_f32_16x16x16_bf16 v[24:27], v[252:253], v[38:39], 0
  v_mfma_f32_16x16x16_bf16 v[28:31], v[252:253], v[40:41], 0
  v_mfma_f32_16x16x16_bf16 v[32:35], v[252:253], v[42:43], 0
  s_nop 4
  v_pk_mul_f32 v[36:37], v[20:21], v[20:21]
  v_pk_mul_f32 v[38:39], v[22:23], v[22:23]
  v_pk_mul_f32 v[40:41], v[24:25], v[24:25]
  v_pk_mul_f32 v[42:43], v[26:27], v[26:27]
  v_pk_fma_f32 v[36:37], v[36:37], s[74:75], v[52:53]
  v_pk_fma_f32 v[38:39], v[38:39], s[74:75], v[52:53]
  v_pk_fma_f32 v[40:41], v[40:41], s[74:75], v[52:53]
  v_pk_fma_f32 v[42:43], v[42:43], s[74:75], v[52:53]
  v_pk_mul_f32 v[36:37], v[36:37], v[20:21]
  v_pk_mul_f32 v[38:39], v[38:39], v[22:23]
  v_pk_mul_f32 v[40:41], v[40:41], v[24:25]
  v_pk_mul_f32 v[42:43], v[42:43], v[26:27]
  v_exp_f32 v36, v36
  v_exp_f32 v37, v37
  v_exp_f32 v38, v38
  v_exp_f32 v39, v39
  v_exp_f32 v40, v40
  v_exp_f32 v41, v41
  v_exp_f32 v42, v42
  v_exp_f32 v43, v43
  v_pk_add_f32 v[36:37], v[36:37], 1.0 op_sel_hi:[1,0]
  v_pk_add_f32 v[38:39], v[38:39], 1.0 op_sel_hi:[1,0]
  v_pk_add_f32 v[40:41], v[40:41], 1.0 op_sel_hi:[1,0]
  v_pk_add_f32 v[42:43], v[42:43], 1.0 op_sel_hi:[1,0]
  v_rcp_f32 v36, v36
  v_rcp_f32 v37, v37
  v_rcp_f32 v38, v38
  v_rcp_f32 v39, v39
  v_rcp_f32 v40, v40
  v_rcp_f32 v41, v41
  v_rcp_f32 v42, v42
  v_rcp_f32 v43, v43
  v_pk_mul_f32 v[36:37], v[36:37], v[20:21]
  v_pk_mul_f32 v[38:39], v[38:39], v[22:23]
  v_pk_mul_f32 v[40:41], v[40:41], v[24:25]
  v_pk_mul_f32 v[42:43], v[42:43], v[26:27]
  v_cvt_pk_bf16_f32 v44, v36, v40
  v_cvt_pk_bf16_f32 v45, v37, v41
  v_cvt_pk_bf16_f32 v46, v38, v42
  v_cvt_pk_bf16_f32 v47, v39, v43
  s_nop 1
  v_mfma_f32_16x16x32_bf16 v[152:155], v[248:251], v[44:47], v[152:155]
  global_load_dwordx4 v[172:175], v12, s[0:1] offset:3072 nt
  v_pk_mul_f32 v[36:37], v[28:29], v[28:29]
  v_pk_mul_f32 v[38:39], v[30:31], v[30:31]
  v_pk_mul_f32 v[40:41], v[32:33], v[32:33]
  v_pk_mul_f32 v[42:43], v[34:35], v[34:35]
  v_pk_fma_f32 v[36:37], v[36:37], s[74:75], v[52:53]
  v_pk_fma_f32 v[38:39], v[38:39], s[74:75], v[52:53]
  v_pk_fma_f32 v[40:41], v[40:41], s[74:75], v[52:53]
  v_pk_fma_f32 v[42:43], v[42:43], s[74:75], v[52:53]
  v_pk_mul_f32 v[36:37], v[36:37], v[28:29]
  v_pk_mul_f32 v[38:39], v[38:39], v[30:31]
  v_pk_mul_f32 v[40:41], v[40:41], v[32:33]
  v_pk_mul_f32 v[42:43], v[42:43], v[34:35]
  v_exp_f32 v36, v36
  v_exp_f32 v37, v37
  v_exp_f32 v38, v38
  v_exp_f32 v39, v39
  v_exp_f32 v40, v40
  v_exp_f32 v41, v41
  v_exp_f32 v42, v42
  v_exp_f32 v43, v43
  v_pk_add_f32 v[36:37], v[36:37], 1.0 op_sel_hi:[1,0]
  v_pk_add_f32 v[38:39], v[38:39], 1.0 op_sel_hi:[1,0]
  v_pk_add_f32 v[40:41], v[40:41], 1.0 op_sel_hi:[1,0]
  v_pk_add_f32 v[42:43], v[42:43], 1.0 op_sel_hi:[1,0]
  v_rcp_f32 v36, v36
  v_rcp_f32 v37, v37
  v_rcp_f32 v38, v38
  v_rcp_f32 v39, v39
  v_rcp_f32 v40, v40
  v_rcp_f32 v41, v41
  v_rcp_f32 v42, v42
  v_rcp_f32 v43, v43
  v_pk_mul_f32 v[36:37], v[36:37], v[28:29]
  v_pk_mul_f32 v[38:39], v[38:39], v[30:31]
  v_pk_mul_f32 v[40:41], v[40:41], v[32:33]
  v_pk_mul_f32 v[42:43], v[42:43], v[34:35]
  v_cvt_pk_bf16_f32 v48, v36, v40
  v_cvt_pk_bf16_f32 v49, v37, v41
  v_cvt_pk_bf16_f32 v50, v38, v42
  v_cvt_pk_bf16_f32 v51, v39, v43
  s_nop 1
  v_mfma_f32_16x16x32_bf16 v[156:159], v[248:251], v[48:51], v[156:159]
  s_barrier
  s_add_u32 s0, s8, s53
  s_addc_u32 s1, s9, 0
  global_load_dwordx4 v[176:179], v12, s[0:1] offset:0 nt
  global_load_dwordx4 v[180:183], v12, s[0:1] offset:1024 nt
  s_mov_b32 s60, 0
  s_mov_b32 s61, 65535
  v_add_u32 v18, 16, v17
  v_mov_b32_dpp v248, v244 row_newbcast:5 row_mask:0xf bank_mask:0xf
  v_mov_b32_dpp v249, v245 row_newbcast:5 row_mask:0xf bank_mask:0xf
  v_mov_b32_dpp v250, v246 row_newbcast:5 row_mask:0xf bank_mask:0xf
  v_mov_b32_dpp v251, v247 row_newbcast:5 row_mask:0xf bank_mask:0xf
  v_cndmask_b32 v36, v1, v17, s[60:61]
  v_mov_b32 v37, 0
  v_mov_b32 v38, 0
  v_cndmask_b32 v39, v1, v17, s[60:61]
  v_cndmask_b32 v40, v1, v18, s[60:61]
  v_mov_b32 v41, 0
  v_mov_b32 v42, 0
  v_cndmask_b32 v43, v1, v18, s[60:61]
  v_mfma_f32_16x16x16_bf16 v[20:23], v[254:255], v[36:37], 0
  v_mfma_f32_16x16x16_bf16 v[24:27], v[254:255], v[38:39], 0
  v_mfma_f32_16x16x16_bf16 v[28:31], v[254:255], v[40:41], 0
  v_mfma_f32_16x16x16_bf16 v[32:35], v[254:255], v[42:43], 0
  s_nop 4
  v_pk_mul_f32 v[36:37], v[20:21], v[20:21]
  v_pk_mul_f32 v[38:39], v[22:23], v[22:23]
  v_pk_mul_f32 v[40:41], v[24:25], v[24:25]
  v_pk_mul_f32 v[42:43], v[26:27], v[26:27]
  v_pk_fma_f32 v[36:37], v[36:37], s[74:75], v[52:53]
  v_pk_fma_f32 v[38:39], v[38:39], s[74:75], v[52:53]
  v_pk_fma_f32 v[40:41], v[40:41], s[74:75], v[52:53]
  v_pk_fma_f32 v[42:43], v[42:43], s[74:75], v[52:53]
  v_pk_mul_f32 v[36:37], v[36:37], v[20:21]
  v_pk_mul_f32 v[38:39], v[38:39], v[22:23]
  v_pk_mul_f32 v[40:41], v[40:41], v[24:25]
  v_pk_mul_f32 v[42:43], v[42:43], v[26:27]
  v_exp_f32 v36, v36
  v_exp_f32 v37, v37
  v_exp_f32 v38, v38
  v_exp_f32 v39, v39
  v_exp_f32 v40, v40
  v_exp_f32 v41, v41
  v_exp_f32 v42, v42
  v_exp_f32 v43, v43
  v_pk_add_f32 v[36:37], v[36:37], 1.0 op_sel_hi:[1,0]
  v_pk_add_f32 v[38:39], v[38:39], 1.0 op_sel_hi:[1,0]
  v_pk_add_f32 v[40:41], v[40:41], 1.0 op_sel_hi:[1,0]
  v_pk_add_f32 v[42:43], v[42:43], 1.0 op_sel_hi:[1,0]
  v_rcp_f32 v36, v36
  v_rcp_f32 v37, v37
  v_rcp_f32 v38, v38
  v_rcp_f32 v39, v39
  v_rcp_f32 v40, v40
  v_rcp_f32 v41, v41
  v_rcp_f32 v42, v42
  v_rcp_f32 v43, v43
  v_pk_mul_f32 v[36:37], v[36:37], v[20:21]
  v_pk_mul_f32 v[38:39], v[38:39], v[22:23]
  v_pk_mul_f32 v[40:41], v[40:41], v[24:25]
  v_pk_mul_f32 v[42:43], v[42:43], v[26:27]
  v_cvt_pk_bf16_f32 v44, v36, v40
  v_cvt_pk_bf16_f32 v45, v37, v41
  v_cvt_pk_bf16_f32 v46, v38, v42
  v_cvt_pk_bf16_f32 v47, v39, v43
  s_nop 1
  v_mfma_f32_16x16x32_bf16 v[152:155], v[248:251], v[44:47], v[152:155]
  global_load_dwordx4 v[184:187], v12, s[0:1] offset:2048 nt
  global_load_dwordx4 v[188:191], v12, s[0:1] offset:3072 nt
  v_pk_mul_f32 v[36:37], v[28:29], v[28:29]
  v_pk_mul_f32 v[38:39], v[30:31], v[30:31]
  v_pk_mul_f32 v[40:41], v[32:33], v[32:33]
  v_pk_mul_f32 v[42:43], v[34:35], v[34:35]
  v_pk_fma_f32 v[36:37], v[36:37], s[74:75], v[52:53]
  v_pk_fma_f32 v[38:39], v[38:39], s[74:75], v[52:53]
  v_pk_fma_f32 v[40:41], v[40:41], s[74:75], v[52:53]
  v_pk_fma_f32 v[42:43], v[42:43], s[74:75], v[52:53]
  v_pk_mul_f32 v[36:37], v[36:37], v[28:29]
  v_pk_mul_f32 v[38:39], v[38:39], v[30:31]
  v_pk_mul_f32 v[40:41], v[40:41], v[32:33]
  v_pk_mul_f32 v[42:43], v[42:43], v[34:35]
  v_exp_f32 v36, v36
  v_exp_f32 v37, v37
  v_exp_f32 v38, v38
  v_exp_f32 v39, v39
  v_exp_f32 v40, v40
  v_exp_f32 v41, v41
  v_exp_f32 v42, v42
  v_exp_f32 v43, v43
  v_pk_add_f32 v[36:37], v[36:37], 1.0 op_sel_hi:[1,0]
  v_pk_add_f32 v[38:39], v[38:39], 1.0 op_sel_hi:[1,0]
  v_pk_add_f32 v[40:41], v[40:41], 1.0 op_sel_hi:[1,0]
  v_pk_add_f32 v[42:43], v[42:43], 1.0 op_sel_hi:[1,0]
  v_rcp_f32 v36, v36
  v_rcp_f32 v37, v37
  v_rcp_f32 v38, v38
  v_rcp_f32 v39, v39
  v_rcp_f32 v40, v40
  v_rcp_f32 v41, v41
  v_rcp_f32 v42, v42
  v_rcp_f32 v43, v43
  v_pk_mul_f32 v[36:37], v[36:37], v[28:29]
  v_pk_mul_f32 v[38:39], v[38:39], v[30:31]
  v_pk_mul_f32 v[40:41], v[40:41], v[32:33]
  v_pk_mul_f32 v[42:43], v[42:43], v[34:35]
  v_cvt_pk_bf16_f32 v48, v36, v40
  v_cvt_pk_bf16_f32 v49, v37, v41
  v_cvt_pk_bf16_f32 v50, v38, v42
  v_cvt_pk_bf16_f32 v51, v39, v43
  s_nop 1
  v_mfma_f32_16x16x32_bf16 v[156:159], v[248:251], v[48:51], v[156:159]
  s_barrier
  s_add_u32 s0, s8, s54
  s_addc_u32 s1, s9, 0
  global_load_dwordx4 v[192:195], v12, s[0:1] offset:0 nt
  global_load_dwordx4 v[196:199], v12, s[0:1] offset:1024 nt
  s_waitcnt vmcnt(12)
  v_pk_mov_b32 v[28:29], v[88:89], v[88:89] op_sel:[0,1]
  v_pk_mov_b32 v[30:31], v[90:91], v[90:91] op_sel:[0,1]
  v_mov_b32_dpp v88, v92 row_ror:8 row_mask:0xf bank_mask:0xc
  v_mov_b32_dpp v89, v93 row_ror:8 row_mask:0xf bank_mask:0xc
  v_mov_b32_dpp v90, v94 row_ror:8 row_mask:0xf bank_mask:0xc
  v_mov_b32_dpp v91, v95 row_ror:8 row_mask:0xf bank_mask:0xc
  v_mov_b32_dpp v92, v28 row_ror:8 row_mask:0xf bank_mask:0x3
  v_mov_b32_dpp v93, v29 row_ror:8 row_mask:0xf bank_mask:0x3
  v_mov_b32_dpp v94, v30 row_ror:8 row_mask:0xf bank_mask:0x3
  v_mov_b32_dpp v95, v31 row_ror:8 row_mask:0xf bank_mask:0x3
  v_pk_mov_b32 v[32:33], v[96:97], v[96:97] op_sel:[0,1]
  v_pk_mov_b32 v[34:35], v[98:99], v[98:99] op_sel:[0,1]
  v_mov_b32_dpp v96, v100 row_ror:8 row_mask:0xf bank_mask:0xc
  v_mov_b32_dpp v97, v101 row_ror:8 row_mask:0xf bank_mask:0xc
  v_mov_b32_dpp v98, v102 row_ror:8 row_mask:0xf bank_mask:0xc
  v_mov_b32_dpp v99, v103 row_ror:8 row_mask:0xf bank_mask:0xc
  v_mov_b32_dpp v100, v32 row_ror:8 row_mask:0xf bank_mask:0x3
  v_mov_b32_dpp v101, v33 row_ror:8 row_mask:0xf bank_mask:0x3
  v_mov_b32_dpp v102, v34 row_ror:8 row_mask:0xf bank_mask:0x3
  v_mov_b32_dpp v103, v35 row_ror:8 row_mask:0xf bank_mask:0x3
  v_pk_mov_b32 v[28:29], v[104:105], v[104:105] op_sel:[0,1]
  v_pk_mov_b32 v[30:31], v[106:107], v[106:107] op_sel:[0,1]
  v_mov_b32_dpp v104, v108 row_ror:8 row_mask:0xf bank_mask:0xc
  v_mov_b32_dpp v105, v109 row_ror:8 row_mask:0xf bank_mask:0xc
  v_mov_b32_dpp v106, v110 row_ror:8 row_mask:0xf bank_mask:0xc
  v_mov_b32_dpp v107, v111 row_ror:8 row_mask:0xf bank_mask:0xc
  v_mov_b32_dpp v108, v28 row_ror:8 row_mask:0xf bank_mask:0x3
  v_mov_b32_dpp v109, v29 row_ror:8 row_mask:0xf bank_mask:0x3
  v_mov_b32_dpp v110, v30 row_ror:8 row_mask:0xf bank_mask:0x3
  v_mov_b32_dpp v111, v31 row_ror:8 row_mask:0xf bank_mask:0x3
  v_pk_mov_b32 v[32:33], v[112:113], v[112:113] op_sel:[0,1]
  v_pk_mov_b32 v[34:35], v[114:115], v[114:115] op_sel:[0,1]
  v_mov_b32_dpp v112, v116 row_ror:8 row_mask:0xf bank_mask:0xc
  v_mov_b32_dpp v113, v117 row_ror:8 row_mask:0xf bank_mask:0xc
  v_mov_b32_dpp v114, v118 row_ror:8 row_mask:0xf bank_mask:0xc
  v_mov_b32_dpp v115, v119 row_ror:8 row_mask:0xf bank_mask:0xc
  v_mov_b32_dpp v116, v32 row_ror:8 row_mask:0xf bank_mask:0x3
  v_mov_b32_dpp v117, v33 row_ror:8 row_mask:0xf bank_mask:0x3
  v_mov_b32_dpp v118, v34 row_ror:8 row_mask:0xf bank_mask:0x3
  v_mov_b32_dpp v119, v35 row_ror:8 row_mask:0xf bank_mask:0x3
  v_pk_mov_b32 v[28:29], v[120:121], v[120:121] op_sel:[0,1]
  v_pk_mov_b32 v[30:31], v[122:123], v[122:123] op_sel:[0,1]
  v_mov_b32_dpp v120, v124 row_ror:8 row_mask:0xf bank_mask:0xc
  v_mov_b32_dpp v121, v125 row_ror:8 row_mask:0xf bank_mask:0xc
  v_mov_b32_dpp v122, v126 row_ror:8 row_mask:0xf bank_mask:0xc
  v_mov_b32_dpp v123, v127 row_ror:8 row_mask:0xf bank_mask:0xc
  v_mov_b32_dpp v124, v28 row_ror:8 row_mask:0xf bank_mask:0x3
  v_mov_b32_dpp v125, v29 row_ror:8 row_mask:0xf bank_mask:0x3
  v_mov_b32_dpp v126, v30 row_ror:8 row_mask:0xf bank_mask:0x3
  v_mov_b32_dpp v127, v31 row_ror:8 row_mask:0xf bank_mask:0x3
  v_pk_mov_b32 v[32:33], v[128:129], v[128:129] op_sel:[0,1]
  v_pk_mov_b32 v[34:35], v[130:131], v[130:131] op_sel:[0,1]
  v_mov_b32_dpp v128, v132 row_ror:8 row_mask:0xf bank_mask:0xc
  v_mov_b32_dpp v129, v133 row_ror:8 row_mask:0xf bank_mask:0xc
  v_mov_b32_dpp v130, v134 row_ror:8 row_mask:0xf bank_mask:0xc
  v_mov_b32_dpp v131, v135 row_ror:8 row_mask:0xf bank_mask:0xc
  v_mov_b32_dpp v132, v32 row_ror:8 row_mask:0xf bank_mask:0x3
  v_mov_b32_dpp v133, v33 row_ror:8 row_mask:0xf bank_mask:0x3
  v_mov_b32_dpp v134, v34 row_ror:8 row_mask:0xf bank_mask:0x3
  v_mov_b32_dpp v135, v35 row_ror:8 row_mask:0xf bank_mask:0x3
  v_pk_mov_b32 v[28:29], v[136:137], v[136:137] op_sel:[0,1]
  v_pk_mov_b32 v[30:31], v[138:139], v[138:139] op_sel:[0,1]
  v_mov_b32_dpp v136, v140 row_ror:8 row_mask:0xf bank_mask:0xc
  v_mov_b32_dpp v137, v141 row_ror:8 row_mask:0xf bank_mask:0xc
  v_mov_b32_dpp v138, v142 row_ror:8 row_mask:0xf bank_mask:0xc
  v_mov_b32_dpp v139, v143 row_ror:8 row_mask:0xf bank_mask:0xc
  v_mov_b32_dpp v140, v28 row_ror:8 row_mask:0xf bank_mask:0x3
  v_mov_b32_dpp v141, v29 row_ror:8 row_mask:0xf bank_mask:0x3
  v_mov_b32_dpp v142, v30 row_ror:8 row_mask:0xf bank_mask:0x3
  v_mov_b32_dpp v143, v31 row_ror:8 row_mask:0xf bank_mask:0x3
  v_pk_mov_b32 v[32:33], v[144:145], v[144:145] op_sel:[0,1]
  v_pk_mov_b32 v[34:35], v[146:147], v[146:147] op_sel:[0,1]
  v_mov_b32_dpp v144, v148 row_ror:8 row_mask:0xf bank_mask:0xc
  v_mov_b32_dpp v145, v149 row_ror:8 row_mask:0xf bank_mask:0xc
  v_mov_b32_dpp v146, v150 row_ror:8 row_mask:0xf bank_mask:0xc
  v_mov_b32_dpp v147, v151 row_ror:8 row_mask:0xf bank_mask:0xc
  v_mov_b32_dpp v148, v32 row_ror:8 row_mask:0xf bank_mask:0x3
  v_mov_b32_dpp v149, v33 row_ror:8 row_mask:0xf bank_mask:0x3
  v_mov_b32_dpp v150, v34 row_ror:8 row_mask:0xf bank_mask:0x3
  v_mov_b32_dpp v151, v35 row_ror:8 row_mask:0xf bank_mask:0x3
  s_mov_b32 s60, 0
  s_mov_b32 s61, 4294901760
  v_add_u32 v18, 16, v17
  v_mov_b32_dpp v248, v244 row_newbcast:6 row_mask:0xf bank_mask:0xf
  v_mov_b32_dpp v249, v245 row_newbcast:6 row_mask:0xf bank_mask:0xf
  v_mov_b32_dpp v250, v246 row_newbcast:6 row_mask:0xf bank_mask:0xf
  v_mov_b32_dpp v251, v247 row_newbcast:6 row_mask:0xf bank_mask:0xf
  v_cndmask_b32 v36, v1, v17, s[60:61]
  v_mov_b32 v37, 0
  v_mov_b32 v38, 0
  v_cndmask_b32 v39, v1, v17, s[60:61]
  v_cndmask_b32 v40, v1, v18, s[60:61]
  v_mov_b32 v41, 0
  v_mov_b32 v42, 0
  v_cndmask_b32 v43, v1, v18, s[60:61]
  v_mfma_f32_16x16x16_bf16 v[20:23], v[252:253], v[36:37], 0
  v_mfma_f32_16x16x16_bf16 v[24:27], v[252:253], v[38:39], 0
  v_mfma_f32_16x16x16_bf16 v[28:31], v[252:253], v[40:41], 0
  v_mfma_f32_16x16x16_bf16 v[32:35], v[252:253], v[42:43], 0
  s_nop 4
  v_pk_mul_f32 v[36:37], v[20:21], v[20:21]
  v_pk_mul_f32 v[38:39], v[22:23], v[22:23]
  v_pk_mul_f32 v[40:41], v[24:25], v[24:25]
  v_pk_mul_f32 v[42:43], v[26:27], v[26:27]
  v_pk_fma_f32 v[36:37], v[36:37], s[74:75], v[52:53]
  v_pk_fma_f32 v[38:39], v[38:39], s[74:75], v[52:53]
  v_pk_fma_f32 v[40:41], v[40:41], s[74:75], v[52:53]
  v_pk_fma_f32 v[42:43], v[42:43], s[74:75], v[52:53]
  v_pk_mul_f32 v[36:37], v[36:37], v[20:21]
  v_pk_mul_f32 v[38:39], v[38:39], v[22:23]
  v_pk_mul_f32 v[40:41], v[40:41], v[24:25]
  v_pk_mul_f32 v[42:43], v[42:43], v[26:27]
  v_exp_f32 v36, v36
  v_exp_f32 v37, v37
  v_exp_f32 v38, v38
  v_exp_f32 v39, v39
  v_exp_f32 v40, v40
  v_exp_f32 v41, v41
  v_exp_f32 v42, v42
  v_exp_f32 v43, v43
  v_pk_add_f32 v[36:37], v[36:37], 1.0 op_sel_hi:[1,0]
  v_pk_add_f32 v[38:39], v[38:39], 1.0 op_sel_hi:[1,0]
  v_pk_add_f32 v[40:41], v[40:41], 1.0 op_sel_hi:[1,0]
  v_pk_add_f32 v[42:43], v[42:43], 1.0 op_sel_hi:[1,0]
  v_rcp_f32 v36, v36
  v_rcp_f32 v37, v37
  v_rcp_f32 v38, v38
  v_rcp_f32 v39, v39
  v_rcp_f32 v40, v40
  v_rcp_f32 v41, v41
  v_rcp_f32 v42, v42
  v_rcp_f32 v43, v43
  v_pk_mul_f32 v[36:37], v[36:37], v[20:21]
  v_pk_mul_f32 v[38:39], v[38:39], v[22:23]
  v_pk_mul_f32 v[40:41], v[40:41], v[24:25]
  v_pk_mul_f32 v[42:43], v[42:43], v[26:27]
  v_cvt_pk_bf16_f32 v44, v36, v40
  v_cvt_pk_bf16_f32 v45, v37, v41
  v_cvt_pk_bf16_f32 v46, v38, v42
  v_cvt_pk_bf16_f32 v47, v39, v43
  s_nop 1
  v_mfma_f32_16x16x32_bf16 v[152:155], v[248:251], v[44:47], v[152:155]
  s_waitcnt vmcnt(10)
  v_readfirstlane_b32 s58, v54
L_fa3:
  v_sad_u8 v18, v15, 0, 0
  s_nop 1
  v_add_u32_dpp v18, v18, v18 quad_perm:[1,0,3,2] row_mask:0xf bank_mask:0xf
  v_cmp_gt_u32 vcc, 8, v18
  s_cbranch_vccz L_fd4
  global_load_dword v15, v3, s[26:27] sc1
  s_waitcnt vmcnt(0)
  s_sub_u32 s56, s56, 1
  s_cbranch_scc0 L_fa3
  s_branch L_end
L_fd4:
  s_lshl_b32 s3, s3, 1
  v_readlane_b32 s4, v15, s3
  s_add_u32 s3, s3, 1
  v_readlane_b32 s5, v15, s3
  s_lshl_b64 s[50:51], 8, s51
  s_cmp_eq_u64 s[4:5], s[50:51]
  s_cselect_b32 s50, 1, 0
  global_load_dwordx4 v[232:235], v12, s[36:37] sc1
  global_load_dwordx4 v[200:203], v12, s[0:1] offset:2048 nt
  global_load_dwordx4 v[204:207], v12, s[0:1] offset:3072 nt
  v_pk_mul_f32 v[36:37], v[28:29], v[28:29]
  v_pk_mul_f32 v[38:39], v[30:31], v[30:31]
  v_pk_mul_f32 v[40:41], v[32:33], v[32:33]
  v_pk_mul_f32 v[42:43], v[34:35], v[34:35]
  v_pk_fma_f32 v[36:37], v[36:37], s[74:75], v[52:53]
  v_pk_fma_f32 v[38:39], v[38:39], s[74:75], v[52:53]
  v_pk_fma_f32 v[40:41], v[40:41], s[74:75], v[52:53]
  v_pk_fma_f32 v[42:43], v[42:43], s[74:75], v[52:53]
  v_pk_mul_f32 v[36:37], v[36:37], v[28:29]
  v_pk_mul_f32 v[38:39], v[38:39], v[30:31]
  v_pk_mul_f32 v[40:41], v[40:41], v[32:33]
  v_pk_mul_f32 v[42:43], v[42:43], v[34:35]
  v_exp_f32 v36, v36
  v_exp_f32 v37, v37
  v_exp_f32 v38, v38
  v_exp_f32 v39, v39
  v_exp_f32 v40, v40
  v_exp_f32 v41, v41
  v_exp_f32 v42, v42
  v_exp_f32 v43, v43
  v_pk_add_f32 v[36:37], v[36:37], 1.0 op_sel_hi:[1,0]
  v_pk_add_f32 v[38:39], v[38:39], 1.0 op_sel_hi:[1,0]
  v_pk_add_f32 v[40:41], v[40:41], 1.0 op_sel_hi:[1,0]
  v_pk_add_f32 v[42:43], v[42:43], 1.0 op_sel_hi:[1,0]
  v_rcp_f32 v36, v36
  v_rcp_f32 v37, v37
  v_rcp_f32 v38, v38
  v_rcp_f32 v39, v39
  v_rcp_f32 v40, v40
  v_rcp_f32 v41, v41
  v_rcp_f32 v42, v42
  v_rcp_f32 v43, v43
  v_pk_mul_f32 v[36:37], v[36:37], v[28:29]
  v_pk_mul_f32 v[38:39], v[38:39], v[30:31]
  v_pk_mul_f32 v[40:41], v[40:41], v[32:33]
  v_pk_mul_f32 v[42:43], v[42:43], v[34:35]
  v_cvt_pk_bf16_f32 v48, v36, v40
  v_cvt_pk_bf16_f32 v49, v37, v41
  v_cvt_pk_bf16_f32 v50, v38, v42
  v_cvt_pk_bf16_f32 v51, v39, v43
  s_nop 1
  v_mfma_f32_16x16x32_bf16 v[156:159], v[248:251], v[48:51], v[156:159]
  s_add_u32 s0, s8, s55
  s_addc_u32 s1, s9, 0
  global_load_dwordx4 v[208:211], v12, s[0:1] offset:0 nt
  global_load_dwordx4 v[212:215], v12, s[0:1] offset:1024 nt
  global_load_dwordx4 v[216:219], v12, s[0:1] offset:2048 nt
  s_nop 2
  v_mov_b32_dpp v152, v156 quad_perm:[0,1,2,3] row_mask:0x2 bank_mask:0xf
  s_lshl_b32 s4, s33, 8
  v_add_u32 v18, s4, v3
  ds_write_b32 v18, v152 offset:23296
  s_waitcnt lgkmcnt(0)
  s_barrier
  global_load_dwordx4 v[220:223], v12, s[0:1] offset:3072 nt
  s_cmp_lg_u32 s33, 1
  s_cbranch_scc1 L_tp5
  ds_read2st64_b32 v[24:25], v3 offset0:91 offset1:92
  ds_read2st64_b32 v[26:27], v3 offset0:93 offset1:94
  ds_read2st64_b32 v[28:29], v3 offset0:95 offset1:96
  ds_read2st64_b32 v[30:31], v3 offset0:97 offset1:98
  s_waitcnt lgkmcnt(2)
  v_pk_add_f32 v[24:25], v[24:25], v[26:27]
  s_waitcnt lgkmcnt(0)
  v_pk_add_f32 v[28:29], v[28:29], v[30:31]
  v_pk_add_f32 v[24:25], v[24:25], v[28:29]
  v_add_f32 v24, v24, v25
  v_cvt_pk_bf16_f32 v24, v1, v24
  v_add_f32 v24, s58, v24
  s_nop 1
  v_mov_b32_dpp v25, v24 quad_perm:[1,1,3,3] row_mask:0xf bank_mask:0xf
  v_cvt_pk_bf16_f32 v24, v24, v25
  v_mov_b32 v25, 0xfffefffe
  v_pk_min_u16 v24, v24, v25
  v_lshrrev_b32 v25, 1, v3
  s_lshl_b32 s4, s2, 6
  s_add_u32 s4, s4, 786432
  s_add_u32 s4, s28, s4
  s_addc_u32 s5, s29, 0
  s_mov_b64 exec, 0x55555555
  global_store_dword v25, v24, s[4:5] sc1
  s_mov_b64 exec, -1
L_tp5:
  s_waitcnt vmcnt(9)
  v_perm_b32 v152, v164, v160, s70
  v_perm_b32 v156, v164, v160, s71
  v_perm_b32 v153, v172, v168, s70
  v_perm_b32 v157, v172, v168, s71
  v_perm_b32 v160, v165, v161, s70
  v_perm_b32 v164, v165, v161, s71
  v_perm_b32 v168, v166, v162, s70
  v_perm_b32 v172, v166, v162, s71
  v_perm_b32 v161, v173, v169, s70
  v_perm_b32 v165, v173, v169, s71
  v_perm_b32 v169, v174, v170, s70
  v_perm_b32 v173, v174, v170, s71
  v_perm_b32 v154, v180, v176, s70
  v_perm_b32 v158, v180, v176, s71
  v_perm_b32 v176, v167, v163, s70
  v_perm_b32 v180, v167, v163, s71
  v_perm_b32 v162, v181, v177, s70
  v_perm_b32 v166, v181, v177, s71
  v_perm_b32 v177, v175, v171, s70
  v_perm_b32 v181, v175, v171, s71
  v_perm_b32 v170, v182, v178, s70
  v_perm_b32 v174, v182, v178, s71
  v_perm_b32 v178, v183, v179, s70
  v_perm_b32 v182, v183, v179, s71
  v_perm_b32 v155, v188, v184, s70
  v_perm_b32 v159, v188, v184, s71
  v_perm_b32 v163, v189, v185, s70
  v_perm_b32 v167, v189, v185, s71
  v_perm_b32 v171, v190, v186, s70
  v_perm_b32 v175, v190, v186, s71
  v_perm_b32 v179, v191, v187, s70
  v_perm_b32 v183, v191, v187, s71
  s_setprio 2
  v_bfe_u32 v52, v3, 4, 2
  v_add_u32 v52, -1, v52
  v_ashrrev_i32 v52, 31, v52
  s_nop 1
  v_mov_b32_dpp v53, v52 row_ror:4 row_mask:0xf bank_mask:0xf
  v_mov_b32_dpp v54, v52 row_ror:8 row_mask:0xf bank_mask:0xf
  v_mov_b32_dpp v55, v52 row_ror:12 row_mask:0xf bank_mask:0xf
  s_waitcnt vmcnt(6)
  v_mov_b32 v20, v232
  v_mov_b32 v21, v233
  v_mov_b32 v22, v234
  v_mov_b32 v23, v235
  s_nop 0
  s_branch L_qc
L_s0:
  v_lshrrev_b32 v19, 6, v3
  v_bfe_u32 v18, v3, 5, 1
  v_lshl_add_u32 v19, v18, 6, v19
  v_lshlrev_b32 v19, 10, v19
  v_lshl_add_u32 v19, v4, 1, v19
  global_load_dwordx4 v[224:227], v19, s[12:13] nt
  v_add_u32 v19, 0x2000, v19
  global_load_dwordx4 v[228:231], v19, s[12:13] nt
  v_add_u32 v19, 0x2000, v19
  global_load_dwordx4 v[232:235], v19, s[12:13] nt
  v_add_u32 v19, 0x2000, v19
  global_load_dwordx4 v[236:239], v19, s[12:13] nt
  v_add_u32 v19, 0x2000, v19
  s_branch L_loop
L_vb:
  s_waitcnt vmcnt(8)
  v_perm_b32 v184, v196, v192, s70
  v_perm_b32 v188, v196, v192, s71
  v_perm_b32 v185, v204, v200, s70
  v_perm_b32 v189, v204, v200, s71
  v_perm_b32 v192, v197, v193, s70
  v_perm_b32 v196, v197, v193, s71
  v_perm_b32 v200, v198, v194, s70
  v_perm_b32 v204, v198, v194, s71
  v_perm_b32 v193, v205, v201, s70
  v_perm_b32 v197, v205, v201, s71
  v_perm_b32 v201, v206, v202, s70
  v_perm_b32 v205, v206, v202, s71
  s_waitcnt vmcnt(6)
  v_perm_b32 v186, v212, v208, s70
  v_perm_b32 v190, v212, v208, s71
  v_perm_b32 v208, v199, v195, s70
  v_perm_b32 v212, v199, v195, s71
  v_perm_b32 v194, v213, v209, s70
  v_perm_b32 v198, v213, v209, s71
  v_perm_b32 v209, v207, v203, s70
  v_perm_b32 v213, v207, v203, s71
  v_perm_b32 v202, v214, v210, s70
  v_perm_b32 v206, v214, v210, s71
  v_perm_b32 v210, v215, v211, s70
  v_perm_b32 v214, v215, v211, s71
  s_waitcnt vmcnt(4)
  v_perm_b32 v187, v220, v216, s70
  v_perm_b32 v191, v220, v216, s71
  v_perm_b32 v195, v221, v217, s70
  v_perm_b32 v199, v221, v217, s71
  v_perm_b32 v203, v222, v218, s70
  v_perm_b32 v207, v222, v218, s71
  v_perm_b32 v211, v223, v219, s70
  v_perm_b32 v215, v223, v219, s71
  global_load_dwordx4 v[240:243], v19, s[12:13] nt
  v_add_u32 v19, 0x2000, v19
  global_load_dwordx4 v[244:247], v19, s[12:13] nt
  v_add_u32 v19, 0x2000, v19
  global_load_dwordx4 v[248:251], v19, s[12:13] nt
  v_add_u32 v19, 0x2000, v19
  global_load_dwordx4 v[252:255], v19, s[12:13] nt
  s_nop 1
  s_branch L_vr
L_qa:
  global_load_dwordx4 v[20:23], v12, s[36:37] sc1
  s_setprio 2
  v_bfe_u32 v52, v3, 4, 2
  v_add_u32 v52, -1, v52
  v_ashrrev_i32 v52, 31, v52
  s_nop 1
  v_mov_b32_dpp v53, v52 row_ror:4 row_mask:0xf bank_mask:0xf
  v_mov_b32_dpp v54, v52 row_ror:8 row_mask:0xf bank_mask:0xf
  v_mov_b32_dpp v55, v52 row_ror:12 row_mask:0xf bank_mask:0xf
  s_waitcnt vmcnt(0)
L_qc:
  v_max3_u32 v18, v20, v21, v22
  v_max_u32 v18, v18, v23
  v_cmp_eq_u32 vcc, -1, v18
  s_cbranch_vccz L_qd
  s_sub_u32 s56, s56, 1
  s_cbranch_scc0 L_qa
  s_branch L_end
L_qd:
  v_mfma_f32_16x16x32_bf16 v[36:39], v[88:91], v[20:23], 0
  v_mov_b32_dpp v24, v20 row_ror:4 row_mask:0xf bank_mask:0xf
  v_mov_b32_dpp v25, v21 row_ror:4 row_mask:0xf bank_mask:0xf
  v_mfma_f32_16x16x32_bf16 v[40:43], v[108:111], v[20:23], 0
  v_mov_b32_dpp v26, v22 row_ror:4 row_mask:0xf bank_mask:0xf
  v_mov_b32_dpp v27, v23 row_ror:4 row_mask:0xf bank_mask:0xf
  v_mfma_f32_16x16x32_bf16 v[44:47], v[128:131], v[20:23], 0
  v_mov_b32_dpp v28, v20 row_ror:8 row_mask:0xf bank_mask:0xf
  v_mov_b32_dpp v29, v21 row_ror:8 row_mask:0xf bank_mask:0xf
  v_mfma_f32_16x16x32_bf16 v[48:51], v[148:151], v[20:23], 0
  v_mov_b32_dpp v30, v22 row_ror:8 row_mask:0xf bank_mask:0xf
  v_mov_b32_dpp v31, v23 row_ror:8 row_mask:0xf bank_mask:0xf
  v_mfma_f32_16x16x32_bf16 v[36:39], v[100:103], v[24:27], v[36:39]
  v_mov_b32_dpp v32, v20 row_ror:12 row_mask:0xf bank_mask:0xf
  v_mov_b32_dpp v33, v21 row_ror:12 row_mask:0xf bank_mask:0xf
  v_mfma_f32_16x16x32_bf16 v[40:43], v[104:107], v[24:27], v[40:43]
  v_mov_b32_dpp v34, v22 row_ror:12 row_mask:0xf bank_mask:0xf
  v_mov_b32_dpp v35, v23 row_ror:12 row_mask:0xf bank_mask:0xf
  v_mfma_f32_16x16x32_bf16 v[36:39], v[96:99], v[28:31], v[36:39]
  v_mfma_f32_16x16x32_bf16 v[40:43], v[116:119], v[28:31], v[40:43]
  v_mfma_f32_16x16x32_bf16 v[36:39], v[92:95], v[32:35], v[36:39]
  v_mfma_f32_16x16x32_bf16 v[40:43], v[112:115], v[32:35], v[40:43]
  s_cmp_eq_u32 s57, 0
  s_cbranch_scc1 L_s0
L_loop:
  v_mfma_f32_16x16x32_bf16 v[44:47], v[124:127], v[24:27], v[44:47]
  v_mfma_f32_16x16x32_bf16 v[44:47], v[120:123], v[28:31], v[44:47]
  v_mfma_f32_16x16x32_bf16 v[44:47], v[132:135], v[32:35], v[44:47]
  v_mfma_f32_16x16x32_bf16 v[48:51], v[144:147], v[24:27], v[48:51]
  s_nop 1
  v_mov_b32_dpp v36, v40 quad_perm:[0,1,2,3] row_mask:0xf bank_mask:2
  v_mov_b32_dpp v37, v41 quad_perm:[0,1,2,3] row_mask:0xf bank_mask:2
  v_mfma_f32_16x16x32_bf16 v[48:51], v[140:143], v[28:31], v[48:51]
  v_mov_b32_dpp v38, v42 quad_perm:[0,1,2,3] row_mask:0xf bank_mask:2
  v_mov_b32_dpp v39, v43 quad_perm:[0,1,2,3] row_mask:0xf bank_mask:2
  v_mfma_f32_16x16x32_bf16 v[48:51], v[136:139], v[32:35], v[48:51]
  v_mov_b32_dpp v36, v44 quad_perm:[0,1,2,3] row_mask:0xf bank_mask:4
  v_mov_b32_dpp v37, v45 quad_perm:[0,1,2,3] row_mask:0xf bank_mask:4
  v_mov_b32_dpp v38, v46 quad_perm:[0,1,2,3] row_mask:0xf bank_mask:4
  v_mov_b32_dpp v39, v47 quad_perm:[0,1,2,3] row_mask:0xf bank_mask:4
  s_nop 3
  v_mov_b32_dpp v36, v48 quad_perm:[0,1,2,3] row_mask:0xf bank_mask:8
  v_mov_b32_dpp v37, v49 quad_perm:[0,1,2,3] row_mask:0xf bank_mask:8
  v_mov_b32_dpp v38, v50 quad_perm:[0,1,2,3] row_mask:0xf bank_mask:8
  v_mov_b32_dpp v39, v51 quad_perm:[0,1,2,3] row_mask:0xf bank_mask:8
  v_max3_f32 v14, v36, v37, v38
  v_max_f32 v14, v14, v39
  s_nop 1
  v_max_f32_dpp v14, v14, v14 row_ror:4 row_mask:0xf bank_mask:0xf
  s_nop 1
  v_max_f32_dpp v14, v14, v14 row_ror:8 row_mask:0xf bank_mask:0xf
  v_mov_b32 v18, v14
  s_nop 1
  v_permlane16_swap_b32 v18, v14
  v_max_f32 v14, v14, v18
  v_mov_b32 v18, v14
  s_nop 1
  v_permlane32_swap_b32 v18, v14
  v_max_f32 v14, v14, v18
  v_mul_f32 v14, s59, v14
  v_fma_f32 v36, v36, s59, -v14
  v_fma_f32 v37, v37, s59, -v14
  v_fma_f32 v38, v38, s59, -v14
  v_fma_f32 v39, v39, s59, -v14
  v_exp_f32 v36, v36
  v_exp_f32 v37, v37
  v_exp_f32 v38, v38
  v_exp_f32 v39, v39
  v_cvt_pk_bf16_f32 v16, v36, v37
  v_cvt_pk_bf16_f32 v17, v38, v39
  s_setprio 0
  v_and_b32 v20, v16, v52
  v_and_b32 v21, v17, v52
  v_and_b32_dpp v22, v16, v52 row_ror:12 row_mask:0xf bank_mask:0xf
  v_and_b32_dpp v23, v17, v52 row_ror:12 row_mask:0xf bank_mask:0xf
  v_and_b32_dpp v24, v16, v53 row_ror:4 row_mask:0xf bank_mask:0xf
  v_and_b32_dpp v25, v17, v53 row_ror:4 row_mask:0xf bank_mask:0xf
  v_mfma_f32_16x16x32_bf16 v[44:47], v[152:155], v[20:23], 0
  v_and_b32 v26, v16, v53
  v_and_b32 v27, v17, v53
  v_mfma_f32_16x16x32_bf16 v[48:51], v[168:171], v[20:23], 0
  v_and_b32_dpp v28, v16, v54 row_ror:8 row_mask:0xf bank_mask:0xf
  v_and_b32_dpp v29, v17, v54 row_ror:8 row_mask:0xf bank_mask:0xf
  v_add_f32 v36, v36, v37
  v_mfma_f32_16x16x32_bf16 v[44:47], v[156:159], v[24:27], v[44:47]
  v_and_b32_dpp v30, v16, v54 row_ror:4 row_mask:0xf bank_mask:0xf
  v_and_b32_dpp v31, v17, v54 row_ror:4 row_mask:0xf bank_mask:0xf
  v_mfma_f32_16x16x32_bf16 v[48:51], v[172:175], v[24:27], v[48:51]
  v_and_b32_dpp v32, v16, v55 row_ror:12 row_mask:0xf bank_mask:0xf
  v_and_b32_dpp v33, v17, v55 row_ror:12 row_mask:0xf bank_mask:0xf
  v_add_f32 v38, v38, v39
  v_mfma_f32_16x16x32_bf16 v[44:47], v[160:163], v[28:31], v[44:47]
  v_and_b32_dpp v34, v16, v55 row_ror:8 row_mask:0xf bank_mask:0xf
  v_and_b32_dpp v35, v17, v55 row_ror:8 row_mask:0xf bank_mask:0xf
  v_mfma_f32_16x16x32_bf16 v[48:51], v[176:179], v[28:31], v[48:51]
  v_and_b32_dpp v20, v16, v52 row_ror:8 row_mask:0xf bank_mask:0xf
  v_and_b32_dpp v21, v17, v52 row_ror:8 row_mask:0xf bank_mask:0xf
  v_add_f32 v15, v36, v38
  v_mfma_f32_16x16x32_bf16 v[44:47], v[164:167], v[32:35], v[44:47]
  v_and_b32_dpp v22, v16, v52 row_ror:4 row_mask:0xf bank_mask:0xf
  v_and_b32_dpp v23, v17, v52 row_ror:4 row_mask:0xf bank_mask:0xf
  v_mfma_f32_16x16x32_bf16 v[48:51], v[180:183], v[32:35], v[48:51]
  v_and_b32_dpp v24, v16, v53 row_ror:12 row_mask:0xf bank_mask:0xf
  v_and_b32_dpp v25, v17, v53 row_ror:12 row_mask:0xf bank_mask:0xf
  v_add_f32_dpp v15, v15, v15 row_ror:4 row_mask:0xf bank_mask:0xf
  s_cbranch_scc1 L_vb
L_vr:
  v_mfma_f32_16x16x32_bf16 v[44:47], v[184:187], v[20:23], v[44:47]
  v_and_b32_dpp v26, v16, v53 row_ror:8 row_mask:0xf bank_mask:0xf
  v_and_b32_dpp v27, v17, v53 row_ror:8 row_mask:0xf bank_mask:0xf
  v_mfma_f32_16x16x32_bf16 v[48:51], v[200:203], v[20:23], v[48:51]
  v_and_b32 v28, v16, v54
  v_and_b32 v29, v17, v54
  v_add_f32_dpp v15, v15, v15 row_ror:8 row_mask:0xf bank_mask:0xf
  v_mfma_f32_16x16x32_bf16 v[44:47], v[188:191], v[24:27], v[44:47]
  v_and_b32_dpp v30, v16, v54 row_ror:12 row_mask:0xf bank_mask:0xf
  v_and_b32_dpp v31, v17, v54 row_ror:12 row_mask:0xf bank_mask:0xf
  v_mov_b32 v18, v15
  v_mfma_f32_16x16x32_bf16 v[48:51], v[204:207], v[24:27], v[48:51]
  v_and_b32_dpp v32, v16, v55 row_ror:4 row_mask:0xf bank_mask:0xf
  v_and_b32_dpp v33, v17, v55 row_ror:4 row_mask:0xf bank_mask:0xf
  v_permlane16_swap_b32 v18, v15
  v_mfma_f32_16x16x32_bf16 v[44:47], v[192:195], v[28:31], v[44:47]
  v_and_b32 v34, v16, v55
  v_and_b32 v35, v17, v55
  v_add_f32 v15, v15, v18
  v_mfma_f32_16x16x32_bf16 v[48:51], v[208:211], v[28:31], v[48:51]
  v_mov_b32 v18, v15
  v_mfma_f32_16x16x32_bf16 v[44:47], v[196:199], v[32:35], v[44:47]
  v_mfma_f32_16x16x32_bf16 v[48:51], v[212:215], v[32:35], v[48:51]
  v_permlane32_swap_b32 v18, v15
  v_add_f32 v15, v15, v18
  s_mov_b64 exec, 15
  ds_write_b64 v7, v[14:15]
  s_mov_b64 exec, -1
  s_nop 1
  ds_write_b128 v5, v[44:47] offset:0
  ds_write_b128 v5, v[48:51] offset:8256
  s_waitcnt lgkmcnt(0)
  s_barrier
  ds_read_b64 v[28:29], v8
  ds_read2st64_b32 v[20:21], v6 offset0:0 offset1:1
  ds_read2st64_b32 v[22:23], v6 offset0:2 offset1:3
  ds_read2st64_b32 v[24:25], v6 offset0:4 offset1:5
  ds_read2st64_b32 v[26:27], v6 offset0:6 offset1:7
  v_and_b32 v18, 0xc0, v3
  v_bfe_u32 v34, v3, 1, 5
  v_lshl_add_u32 v34, v18, 2, v34
  v_lshrrev_b32 v19, 4, v3
  v_xor_b32 v19, v19, v3
  v_and_b32 v19, 12, v19
  v_lshlrev_b32 v19, 2, v19
  s_waitcnt lgkmcnt(4)
  v_mov_b32 v18, v28
  v_max_f32_dpp v28, v28, v28 quad_perm:[1,0,3,2] row_mask:0xf bank_mask:0xf
  s_nop 1
  v_max_f32_dpp v28, v28, v28 quad_perm:[2,3,0,1] row_mask:0xf bank_mask:0xf
  s_nop 1
  v_max_f32_dpp v28, v28, v28 row_half_mirror row_mask:0xf bank_mask:0xf
  v_sub_f32 v18, v18, v28
  v_exp_f32 v18, v18
  v_min_u32 v28, -2, v28
  v_mul_f32 v29, v18, v29
  s_waitcnt lgkmcnt(0)
  v_mul_f32_dpp v32, v18, v20 row_newbcast:0 row_mask:0xf bank_mask:0xf
  v_mul_f32_dpp v33, v18, v21 row_newbcast:1 row_mask:0xf bank_mask:0xf
  v_add_f32_dpp v29, v29, v29 quad_perm:[1,0,3,2] row_mask:0xf bank_mask:0xf
  v_fmac_f32_dpp v32, v18, v22 row_newbcast:2 row_mask:0xf bank_mask:0xf
  v_fmac_f32_dpp v33, v18, v23 row_newbcast:3 row_mask:0xf bank_mask:0xf
  v_add_f32_dpp v29, v29, v29 quad_perm:[2,3,0,1] row_mask:0xf bank_mask:0xf
  v_fmac_f32_dpp v32, v18, v24 row_newbcast:4 row_mask:0xf bank_mask:0xf
  v_fmac_f32_dpp v33, v18, v25 row_newbcast:5 row_mask:0xf bank_mask:0xf
  v_add_f32_dpp v29, v29, v29 row_half_mirror row_mask:0xf bank_mask:0xf
  v_fmac_f32_dpp v32, v18, v26 row_newbcast:6 row_mask:0xf bank_mask:0xf
  v_fmac_f32_dpp v33, v18, v27 row_newbcast:7 row_mask:0xf bank_mask:0xf
  v_add_f32 v32, v32, v33
  v_min_u32 v29, -2, v29
  s_nop 0
  v_mov_b32_dpp v33, v32 quad_perm:[1,1,3,3] row_mask:0xf bank_mask:0xf
  v_cvt_pk_bf16_f32 v32, v32, v33
  v_min_u32 v32, -2, v32
  s_cmp_eq_u32 s50, 0
  s_cbranch_scc1 L_ps6
  s_mov_b64 exec, s[68:69]
  global_store_dword v34, v32, s[42:43]
  s_mov_b64 exec, 1
  global_store_dwordx2 v1, v[28:29], s[44:45] offset:1024
  s_mov_b64 exec, -1
L_pd7:
  s_cmp_eq_u32 s57, 0
  s_cbranch_scc0 L_w1
  s_waitcnt vmcnt(6)
  v_perm_b32 v216, v228, v224, s70
  v_perm_b32 v220, v228, v224, s71
  v_perm_b32 v217, v236, v232, s70
  v_perm_b32 v221, v236, v232, s71
  v_perm_b32 v224, v229, v225, s70
  v_perm_b32 v228, v229, v225, s71
  v_perm_b32 v232, v230, v226, s70
  v_perm_b32 v236, v230, v226, s71
  v_perm_b32 v225, v237, v233, s70
  v_perm_b32 v229, v237, v233, s71
  v_perm_b32 v233, v238, v234, s70
  v_perm_b32 v237, v238, v234, s71
L_w1:
  s_barrier
L_oa:
  global_load_dwordx4 v[52:55], v12, s[40:41] sc1
  global_load_dwordx4 v[14:17], v19, s[40:41] offset:1024 sc1
  s_cbranch_scc1 L_w0
L_wr:
  s_waitcnt vmcnt(0)
  v_max3_u32 v18, v52, v53, v54
  v_max3_u32 v18, v18, v55, v14
  v_max3_u32 v18, v18, v15, v16
  v_max_u32 v18, v18, v17
  v_cmp_eq_u32 vcc, -1, v18
  s_cbranch_vccz L_od
  s_sub_u32 s56, s56, 1
  s_cbranch_scc0 L_oa
  s_branch L_end
L_w0:
  s_waitcnt vmcnt(6)
  v_perm_b32 v218, v244, v240, s70
  v_perm_b32 v222, v244, v240, s71
  v_perm_b32 v240, v231, v227, s70
  v_perm_b32 v244, v231, v227, s71
  v_perm_b32 v226, v245, v241, s70
  v_perm_b32 v230, v245, v241, s71
  v_perm_b32 v241, v239, v235, s70
  v_perm_b32 v245, v239, v235, s71
  v_perm_b32 v234, v246, v242, s70
  v_perm_b32 v238, v246, v242, s71
  v_perm_b32 v242, v247, v243, s70
  v_perm_b32 v246, v247, v243, s71
  s_waitcnt vmcnt(4)
  v_perm_b32 v219, v252, v248, s70
  v_perm_b32 v223, v252, v248, s71
  v_perm_b32 v227, v253, v249, s70
  v_perm_b32 v231, v253, v249, s71
  v_perm_b32 v235, v254, v250, s70
  v_perm_b32 v239, v254, v250, s71
  v_perm_b32 v243, v255, v251, s70
  v_perm_b32 v247, v255, v251, s71
  s_branch L_wr
L_od:
  v_max_f32 v18, v14, v16
  v_mfma_f32_16x16x32_bf16 v[20:23], v[52:55], v[216:219], 0
  s_nop 0
  v_max_f32_dpp v18, v18, v18 quad_perm:[1,0,3,2] row_mask:0xf bank_mask:0xf
  v_mfma_f32_16x16x32_bf16 v[24:27], v[52:55], v[220:223], 0
  s_nop 0
  v_max_f32_dpp v18, v18, v18 quad_perm:[2,3,0,1] row_mask:0xf bank_mask:0xf
  v_sub_f32 v14, v14, v18
  v_sub_f32 v16, v16, v18
  v_mfma_f32_16x16x32_bf16 v[28:31], v[52:55], v[224:227], 0
  v_exp_f32 v14, v14
  v_exp_f32 v16, v16
  v_mfma_f32_16x16x32_bf16 v[32:35], v[52:55], v[228:231], 0
  v_mul_f32 v18, v14, v15
  v_fmac_f32 v18, v16, v17
  v_mfma_f32_16x16x32_bf16 v[36:39], v[52:55], v[232:235], 0
  s_nop 0
  v_add_f32_dpp v18, v18, v18 quad_perm:[1,0,3,2] row_mask:0xf bank_mask:0xf
  v_mfma_f32_16x16x32_bf16 v[40:43], v[52:55], v[236:239], 0
  s_nop 0
  v_add_f32_dpp v18, v18, v18 quad_perm:[2,3,0,1] row_mask:0xf bank_mask:0xf
  v_mfma_f32_16x16x32_bf16 v[44:47], v[52:55], v[240:243], 0
  v_rcp_f32 v18, v18
  v_mfma_f32_16x16x32_bf16 v[48:51], v[52:55], v[244:247], 0
  v_mul_f32 v14, v14, v18
  v_mul_f32 v16, v16, v18
  v_add_f32_dpp v20, v21, v20 row_ror:8 row_mask:0xf bank_mask:0x3
  v_add_f32_dpp v24, v25, v24 row_ror:8 row_mask:0xf bank_mask:0x3
  v_add_f32_dpp v28, v29, v28 row_ror:8 row_mask:0xf bank_mask:0x3
  v_add_f32_dpp v32, v33, v32 row_ror:8 row_mask:0xf bank_mask:0x3
  v_add_f32_dpp v22, v23, v22 row_ror:8 row_mask:0xf bank_mask:0x3
  v_add_f32_dpp v26, v27, v26 row_ror:8 row_mask:0xf bank_mask:0x3
  v_add_f32_dpp v30, v31, v30 row_ror:8 row_mask:0xf bank_mask:0x3
  v_add_f32_dpp v34, v35, v34 row_ror:8 row_mask:0xf bank_mask:0x3
  v_add_f32_dpp v20, v36, v37 row_ror:8 row_mask:0xf bank_mask:0xc
  v_add_f32_dpp v24, v40, v41 row_ror:8 row_mask:0xf bank_mask:0xc
  v_add_f32_dpp v28, v44, v45 row_ror:8 row_mask:0xf bank_mask:0xc
  v_add_f32_dpp v32, v48, v49 row_ror:8 row_mask:0xf bank_mask:0xc
  v_add_f32_dpp v22, v38, v39 row_ror:8 row_mask:0xf bank_mask:0xc
  v_add_f32_dpp v26, v42, v43 row_ror:8 row_mask:0xf bank_mask:0xc
  v_add_f32_dpp v30, v46, v47 row_ror:8 row_mask:0xf bank_mask:0xc
  v_add_f32_dpp v34, v50, v51 row_ror:8 row_mask:0xf bank_mask:0xc
  v_mul_f32_dpp v20, v14, v20 quad_perm:[0,0,0,0] row_mask:0xf bank_mask:0xf
  v_mul_f32_dpp v24, v14, v24 quad_perm:[0,0,0,0] row_mask:0xf bank_mask:0xf
  v_mul_f32_dpp v28, v14, v28 quad_perm:[0,0,0,0] row_mask:0xf bank_mask:0xf
  v_mul_f32_dpp v32, v14, v32 quad_perm:[0,0,0,0] row_mask:0xf bank_mask:0xf
  v_fmac_f32_dpp v20, v16, v22 quad_perm:[0,0,0,0] row_mask:0xf bank_mask:0xf
  v_fmac_f32_dpp v24, v16, v26 quad_perm:[0,0,0,0] row_mask:0xf bank_mask:0xf
  v_fmac_f32_dpp v28, v16, v30 quad_perm:[0,0,0,0] row_mask:0xf bank_mask:0xf
  v_fmac_f32_dpp v32, v16, v34 quad_perm:[0,0,0,0] row_mask:0xf bank_mask:0xf
  s_nop 0
  v_permlane32_swap_b32 v20, v28
  v_permlane32_swap_b32 v24, v32
  v_add_f32 v20, v20, v28
  v_add_f32 v24, v24, v32
  s_nop 1
  v_permlane16_swap_b32 v20, v24
  v_add_f32 v20, v20, v24
  ds_write_b32 v11, v20
  s_waitcnt lgkmcnt(0)
  s_barrier
  s_cmp_lg_u32 s33, 0
  s_cbranch_scc1 L_yf8
  ds_read2st64_b32 v[20:21], v3 offset0:73 offset1:74
  ds_read2st64_b32 v[22:23], v3 offset0:75 offset1:76
  ds_read2st64_b32 v[24:25], v3 offset0:77 offset1:78
  ds_read2st64_b32 v[26:27], v3 offset0:79 offset1:80
  s_waitcnt lgkmcnt(2)
  v_pk_add_f32 v[20:21], v[20:21], v[22:23]
  s_waitcnt lgkmcnt(0)
  v_pk_add_f32 v[24:25], v[24:25], v[26:27]
  v_pk_add_f32 v[20:21], v[20:21], v[24:25]
  v_add_f32 v20, v20, v21
  v_min_u32 v20, -2, v20
  global_store_dword v3, v20, s[48:49] sc1
L_yf8:
  s_add_u32 s36, s36, 393216
  s_addc_u32 s37, s37, 0
  s_add_u32 s38, s38, 393216
  s_addc_u32 s39, s39, 0
  s_add_u32 s40, s40, 393216
  s_addc_u32 s41, s41, 0
  s_add_u32 s42, s42, 393216
  s_addc_u32 s43, s43, 0
  s_add_u32 s44, s44, 393216
  s_addc_u32 s45, s45, 0
  s_add_u32 s48, s48, 393216
  s_addc_u32 s49, s49, 0
  s_waitcnt vmcnt(0)
  s_and_b32 s4, s2, 63
  s_mul_i32 s4, s4, s57
  s_cmp_lg_u32 s4, 0
  s_cbranch_scc1 L_end
  s_lshl_b32 s4, s57, 3
  s_sub_u32 s4, s33, s4
  s_cmp_lt_i32 s4, 4
  s_cbranch_scc1 L_tl9
  s_lshl_b32 s14, s33, 12
  s_add_u32 s4, s14, 770048
  s_add_u32 s4, s28, s4
  s_addc_u32 s5, s29, 0
  s_and_b32 s15, s14, 0x2000
  s_mul_i32 s15, s15, 7
  s_add_u32 s14, s14, s15
  s_add_u32 m0, s14, 9216
  s_nop 0
  global_load_lds_dwordx4 v12, s[4:5] offset:0 sc1
  global_load_lds_dwordx4 v12, s[4:5] offset:1024 sc1
  global_load_lds_dwordx4 v12, s[4:5] offset:2048 sc1
  global_load_lds_dwordx4 v12, s[4:5] offset:3072 sc1
L_tl9:
  v_mov_b32 v30, 0
  s_barrier
L_pa10:
  global_load_dword v20, v3, s[46:47] offset:0 sc1
  global_load_dword v21, v3, s[46:47] offset:256 sc1
  global_load_dword v22, v3, s[46:47] offset:512 sc1
  global_load_dword v23, v3, s[46:47] offset:768 sc1
  global_load_dword v24, v3, s[46:47] offset:1024 sc1
  global_load_dword v25, v3, s[46:47] offset:1280 sc1
  global_load_dword v26, v3, s[46:47] offset:1536 sc1
  global_load_dword v27, v3, s[46:47] offset:1792 sc1
  s_waitcnt vmcnt(0)
L_pb11:
  v_max3_u32 v18, v20, v21, v22
  v_max3_u32 v18, v18, v23, v24
  v_max3_u32 v18, v18, v25, v26
  v_max_u32 v18, v18, v27
  v_cmp_eq_u32 vcc, -1, v18
  s_cbranch_vccz L_pd12
  s_sub_u32 s56, s56, 1
  s_cbranch_scc0 L_pa10
  s_branch L_end
L_pd12:
  v_pk_add_f32 v[20:21], v[20:21], v[22:23]
  v_pk_add_f32 v[24:25], v[24:25], v[26:27]
  v_pk_add_f32 v[20:21], v[20:21], v[24:25]
  v_add_f32 v20, v20, v21
  v_cvt_pk_bf16_f32 v20, v1, v20
  v_add_f32 v0, v0, v20
  v_cvt_pk_bf16_f32 v0, v1, v0
  v_mul_f32 v19, v0, v0
  s_nop 0
  v_add_f32_dpp v18, v0, v0 quad_perm:[1,0,3,2] row_mask:0xf bank_mask:0xf
  v_add_f32_dpp v19, v19, v19 quad_perm:[1,0,3,2] row_mask:0xf bank_mask:0xf
  s_nop 0
  v_add_f32_dpp v18, v18, v18 quad_perm:[2,3,0,1] row_mask:0xf bank_mask:0xf
  v_add_f32_dpp v19, v19, v19 quad_perm:[2,3,0,1] row_mask:0xf bank_mask:0xf
  s_nop 0
  v_add_f32_dpp v18, v18, v18 row_half_mirror row_mask:0xf bank_mask:0xf
  v_add_f32_dpp v19, v19, v19 row_half_mirror row_mask:0xf bank_mask:0xf
  s_nop 0
  v_add_f32_dpp v18, v18, v18 row_mirror row_mask:0xf bank_mask:0xf
  v_add_f32_dpp v19, v19, v19 row_mirror row_mask:0xf bank_mask:0xf
  s_nop 0
  v_add_f32_dpp v18, v18, v18 row_bcast:15 row_mask:0xa bank_mask:0xf
  v_add_f32_dpp v19, v19, v19 row_bcast:15 row_mask:0xa bank_mask:0xf
  s_nop 0
  v_add_f32_dpp v18, v18, v18 row_bcast:31 row_mask:0xc bank_mask:0xf
  v_add_f32_dpp v19, v19, v19 row_bcast:31 row_mask:0xc bank_mask:0xf
  s_brev_b64 exec, 1
  ds_write_b64 v13, v[18:19] offset:22784
  s_mov_b64 exec, -1
  s_add_u32 s46, s46, 393216
  s_addc_u32 s47, s47, 0
  s_waitcnt lgkmcnt(0)
  s_barrier
  ds_read_b64 v[18:19], v4 offset:22784
  s_waitcnt lgkmcnt(0)
  v_add_f32_dpp v18, v18, v18 quad_perm:[1,0,3,2] row_mask:0xf bank_mask:0xf
  v_add_f32_dpp v19, v19, v19 quad_perm:[1,0,3,2] row_mask:0xf bank_mask:0xf
  s_nop 0
  v_add_f32_dpp v18, v18, v18 quad_perm:[2,3,0,1] row_mask:0xf bank_mask:0xf
  v_add_f32_dpp v19, v19, v19 quad_perm:[2,3,0,1] row_mask:0xf bank_mask:0xf
  s_nop 0
  v_add_f32_dpp v18, v18, v18 row_half_mirror row_mask:0xf bank_mask:0xf
  v_add_f32_dpp v19, v19, v19 row_half_mirror row_mask:0xf bank_mask:0xf
  v_pk_mul_f32 v[18:19], v[18:19], s[62:63]
  v_fma_f32 v19, -v18, v18, v19
  v_max_f32 v19, 0, v19
  v_mul_f32 v19, 0x3f800054, v19
  v_add_f32 v19, 0x2edbe6ff, v19
  v_rsq_f32 v19, v19
  v_sub_f32 v28, v0, v18
  v_mul_f32 v28, v28, v19
  v_cvt_pk_bf16_f32 v28, v28, v1
  v_lshlrev_b32 v18, 1, v28
  ds_read_u16_d16_hi v30, v18
  v_and_b32 v19, 0x7fff, v28
  v_add_u32 v19, 4294954496, v19
  v_cmp_lt_u32 vcc, 0xfff, v19
  s_mov_b64 s[14:15], vcc
  s_waitcnt lgkmcnt(0)
  v_cmp_eq_u32 vcc, 0xffff0000, v30
  s_or_b64 vcc, vcc, s[14:15]
  s_cbranch_scc1 L_slow
L_back:
  v_add_f32 v0, v0, v30
  v_cvt_pk_bf16_f32 v0, v1, v0
  s_cmp_lg_u32 s57, 0
  s_cbranch_scc1 L_out
  s_mov_b32 s57, 1
L_qp:
  ds_write_b16_d16_hi v9, v0
  ds_read_b128 v[52:55], v10
  v_mul_f32 v19, v0, v0
  v_add_f32_dpp v18, v0, v0 quad_perm:[1,0,3,2] row_mask:0xf bank_mask:0xf
  s_cmp_eq_u32 s57, 0
  v_add_f32_dpp v19, v19, v19 quad_perm:[1,0,3,2] row_mask:0xf bank_mask:0xf
  v_add_f32_dpp v18, v18, v18 quad_perm:[2,3,0,1] row_mask:0xf bank_mask:0xf
  s_nop 0
  v_add_f32_dpp v19, v19, v19 quad_perm:[2,3,0,1] row_mask:0xf bank_mask:0xf
  s_waitcnt lgkmcnt(0)
  s_cbranch_scc1 L_q1
L_q1b:
  v_mfma_f32_16x16x32_bf16 v[20:23], v[52:55], v[56:59], 0
  v_add_f32_dpp v18, v18, v18 row_half_mirror row_mask:0xf bank_mask:0xf
  v_add_f32_dpp v19, v19, v19 row_half_mirror row_mask:0xf bank_mask:0xf
  v_mfma_f32_16x16x32_bf16 v[24:27], v[52:55], v[60:63], 0
  v_add_f32_dpp v18, v18, v18 row_mirror row_mask:0xf bank_mask:0xf
  v_add_f32_dpp v19, v19, v19 row_mirror row_mask:0xf bank_mask:0xf
  v_mfma_f32_16x16x32_bf16 v[28:31], v[52:55], v[64:67], 0
  v_add_f32_dpp v18, v18, v18 row_bcast:15 row_mask:0xa bank_mask:0xf
  v_add_f32_dpp v19, v19, v19 row_bcast:15 row_mask:0xa bank_mask:0xf
  v_mfma_f32_16x16x32_bf16 v[32:35], v[52:55], v[68:71], 0
  v_add_f32_dpp v18, v18, v18 row_bcast:31 row_mask:0xc bank_mask:0xf
  v_add_f32_dpp v19, v19, v19 row_bcast:31 row_mask:0xc bank_mask:0xf
  v_mfma_f32_16x16x32_bf16 v[36:39], v[52:55], v[72:75], 0
  s_brev_b64 exec, 1
  ds_write_b64 v13, v[18:19] offset:22848
  s_mov_b64 exec, -1
  v_mfma_f32_16x16x32_bf16 v[40:43], v[52:55], v[76:79], 0
  v_add_f32_dpp v20, v21, v20 row_ror:8 row_mask:0xf bank_mask:0x3
  v_mfma_f32_16x16x32_bf16 v[44:47], v[52:55], v[80:83], 0
  v_add_f32_dpp v21, v25, v24 row_ror:8 row_mask:0xf bank_mask:0x3
  v_mfma_f32_16x16x32_bf16 v[48:51], v[52:55], v[84:87], 0
  v_add_f32_dpp v22, v29, v28 row_ror:8 row_mask:0xf bank_mask:0x3
  v_add_f32_dpp v23, v33, v32 row_ror:8 row_mask:0xf bank_mask:0x3
  v_add_f32_dpp v20, v36, v37 row_ror:8 row_mask:0xf bank_mask:0xc
  s_nop 0
  v_add_f32_dpp v21, v40, v41 row_ror:8 row_mask:0xf bank_mask:0xc
  s_nop 0
  v_add_f32_dpp v22, v44, v45 row_ror:8 row_mask:0xf bank_mask:0xc
  s_nop 0
  v_add_f32_dpp v23, v48, v49 row_ror:8 row_mask:0xf bank_mask:0xc
  s_mov_b64 exec, 0xffff
  ds_write_b128 v11, v[20:23]
  s_cbranch_scc1 L_q2
L_q2b:
  s_mov_b64 exec, -1
  s_waitcnt lgkmcnt(0)
  s_barrier
  s_cmp_lg_u32 s33, 0
  s_cbranch_scc1 L_qf13
  s_cmp_eq_u32 s57, 0
  s_cbranch_scc1 L_q3
L_q3b:
  ds_read_b64 v[18:19], v4 offset:22848
  ds_read_b32 v28, v3 offset:22912
  ds_read2st64_b32 v[20:21], v3 offset0:73 offset1:74
  ds_read2st64_b32 v[22:23], v3 offset0:75 offset1:76
  ds_read2st64_b32 v[24:25], v3 offset0:77 offset1:78
  ds_read2st64_b32 v[26:27], v3 offset0:79 offset1:80
  s_waitcnt lgkmcnt(5)
  v_add_f32_dpp v18, v18, v18 quad_perm:[1,0,3,2] row_mask:0xf bank_mask:0xf
  v_add_f32_dpp v19, v19, v19 quad_perm:[1,0,3,2] row_mask:0xf bank_mask:0xf
  s_waitcnt lgkmcnt(2)
  v_pk_add_f32 v[20:21], v[20:21], v[22:23]
  v_add_f32_dpp v18, v18, v18 quad_perm:[2,3,0,1] row_mask:0xf bank_mask:0xf
  v_add_f32_dpp v19, v19, v19 quad_perm:[2,3,0,1] row_mask:0xf bank_mask:0xf
  s_waitcnt lgkmcnt(0)
  v_pk_add_f32 v[24:25], v[24:25], v[26:27]
  v_add_f32_dpp v18, v18, v18 row_half_mirror row_mask:0xf bank_mask:0xf
  v_add_f32_dpp v19, v19, v19 row_half_mirror row_mask:0xf bank_mask:0xf
  v_pk_mul_f32 v[18:19], v[18:19], s[62:63]
  v_fma_f32 v19, -v18, v18, v19
  v_max_f32 v19, 0, v19
  v_add_f32 v19, 0x3727c5ac, v19
  v_rsq_f32 v19, v19
  v_pk_add_f32 v[20:21], v[20:21], v[24:25]
  v_add_f32 v20, v20, v21
  v_fma_f32 v20, -v18, v28, v20
  v_mul_f32 v20, v19, v20
  s_nop 1
  v_mov_b32_dpp v21, v20 quad_perm:[1,1,3,3] row_mask:0xf bank_mask:0xf
  v_cvt_pk_bf16_f32 v20, v20, v21
  v_min_u32 v20, -2, v20
  s_mov_b64 exec, s[68:69]
  s_cmp_eq_u32 s50, 0
  s_cbranch_scc1 L_ps14
  global_store_dword v2, v20, s[38:39]
L_pd15:
  s_mov_b64 exec, -1
L_qf13:
  s_cmp_eq_u32 s57, 0
  s_cbranch_scc1 L_qr
  s_barrier
  s_branch L_qa
L_out:
  s_lshl_b32 s14, s33, 7
  v_lshrrev_b32 v18, 1, v3
  v_add_u32 v18, s14, v18
  global_store_short_d16_hi v18, v0, s[24:25]
L_end:
L_exit:
  s_endpgm
L_slow:
  s_andn2_b64 exec, vcc, s[14:15]
  s_cbranch_scc0 L_slow0
  s_mov_b32 s4, 786432
  s_add_u32 s4, s28, s4
  s_addc_u32 s5, s29, 0
  v_lshrrev_b32 v18, 15, v28
  v_lshl_add_u32 v18, v18, 12, v19
  v_lshlrev_b32 v18, 1, v18
L_slowt:
  global_load_short_d16_hi v30, v18, s[4:5] sc1
  s_waitcnt vmcnt(0)
  v_cmp_eq_u32 vcc, 0xffff0000, v30
  s_cbranch_vccz L_slow0
  s_sub_u32 s56, s56, 1
  s_cbranch_scc0 L_slowt
  s_branch L_exit
L_slow0:
  s_mov_b64 exec, -1
  s_cmp_eq_u64 s[14:15], 0
  s_cbranch_scc1 L_back
L_slow1:
  s_ff1_i32_b64 s3, s[14:15]
  v_readlane_b32 s35, v28, s3
  s_lshl_b32 s3, s35, 16
  v_mov_b32 v20, 0
  v_mov_b32 v21, v3
  s_mov_b32 s4, 14
L_slow2:
  global_load_dword v22, v21, s[16:17]
  global_load_dword v23, v21, s[18:19]
  global_load_dword v24, v21, s[20:21]
  s_waitcnt vmcnt(0)
  v_lshlrev_b32 v25, 16, v22
  v_lshlrev_b32 v26, 16, v23
  v_lshlrev_b32 v27, 16, v24
  v_fma_f32 v25, v25, s3, v26
  v_mul_f32 v26, v25, v25
  v_mov_b32 v18, s72
  v_fma_f32 v26, v26, s74, v18
  v_mul_f32 v26, v26, v25
  v_exp_f32 v26, v26
  s_nop 0
  v_add_f32 v26, 1.0, v26
  v_rcp_f32 v26, v26
  s_nop 0
  v_mul_f32 v26, v26, v25
  v_cvt_pk_bf16_f32 v26, v1, v26
  v_fmac_f32 v20, v26, v27
  v_and_b32 v25, 0xffff0000, v22
  v_and_b32 v26, 0xffff0000, v23
  v_and_b32 v27, 0xffff0000, v24
  v_fma_f32 v25, v25, s3, v26
  v_mul_f32 v26, v25, v25
  v_mov_b32 v18, s72
  v_fma_f32 v26, v26, s74, v18
  v_mul_f32 v26, v26, v25
  v_exp_f32 v26, v26
  s_nop 0
  v_add_f32 v26, 1.0, v26
  v_rcp_f32 v26, v26
  s_nop 0
  v_mul_f32 v26, v26, v25
  v_cvt_pk_bf16_f32 v26, v1, v26
  v_fmac_f32 v20, v26, v27
  v_add_u32 v21, 256, v21
  s_sub_u32 s4, s4, 1
  s_cmp_lg_u32 s4, 0
  s_cbranch_scc1 L_slow2
  v_add_f32_dpp v20, v20, v20 quad_perm:[1,0,3,2] row_mask:0xf bank_mask:0xf
  s_nop 1
  v_add_f32_dpp v20, v20, v20 quad_perm:[2,3,0,1] row_mask:0xf bank_mask:0xf
  s_nop 1
  v_add_f32_dpp v20, v20, v20 row_half_mirror row_mask:0xf bank_mask:0xf
  s_nop 1
  v_add_f32_dpp v20, v20, v20 row_mirror row_mask:0xf bank_mask:0xf
  s_nop 1
  v_add_f32_dpp v20, v20, v20 row_bcast:15 row_mask:0xa bank_mask:0xf
  s_nop 1
  v_add_f32_dpp v20, v20, v20 row_bcast:31 row_mask:0xc bank_mask:0xf
  v_cvt_pk_bf16_f32 v20, v1, v20
  v_add_f32 v20, s58, v20
  v_cvt_pk_bf16_f32 v20, v1, v20
  s_nop 0
  v_readlane_b32 s4, v20, 63
  v_cmp_eq_u32 vcc, s35, v28
  s_nop 0
  v_mov_b32 v20, s4
  v_cndmask_b32 v30, v30, v20, vcc
  s_andn2_b64 s[14:15], s[14:15], vcc
  s_cbranch_scc1 L_slow1
  s_branch L_back
L_ps6:
  s_nop 4
  s_mov_b64 exec, s[68:69]
  global_store_dword v34, v32, s[42:43] sc1
  s_mov_b64 exec, 1
  global_store_dwordx2 v1, v[28:29], s[44:45] offset:1024 sc1
  s_mov_b64 exec, -1
  s_waitcnt vmcnt(0)
  s_branch L_pd7
L_q1:
  v_mov_b32 v20, 0x3f803f80
  s_nop 1
  v_mov_b32_dpp v52, v20 quad_perm:[0,1,2,3] row_mask:0xf bank_mask:0x2
  v_mov_b32_dpp v53, v20 quad_perm:[0,1,2,3] row_mask:0xf bank_mask:0x2
  v_mov_b32_dpp v54, v20 quad_perm:[0,1,2,3] row_mask:0xf bank_mask:0x2
  v_mov_b32_dpp v55, v20 quad_perm:[0,1,2,3] row_mask:0xf bank_mask:0x2
  s_nop 1
  s_branch L_q1b
L_q2:
  s_mov_b32 exec_lo, 0xffff0000
  ds_write_b128 v11, v[20:23] offset:2044
  s_branch L_q2b
L_q3:
  ds_read2st64_b32 v[28:29], v3 offset0:81 offset1:82
  ds_read2st64_b32 v[30:31], v3 offset0:83 offset1:84
  ds_read2st64_b32 v[32:33], v3 offset0:85 offset1:86
  ds_read2st64_b32 v[34:35], v3 offset0:87 offset1:88
  s_waitcnt lgkmcnt(2)
  v_pk_add_f32 v[28:29], v[28:29], v[30:31]
  s_waitcnt lgkmcnt(0)
  v_pk_add_f32 v[32:33], v[32:33], v[34:35]
  v_pk_add_f32 v[28:29], v[28:29], v[32:33]
  v_add_f32 v28, v28, v29
  ds_write_b32 v3, v28 offset:22912
  s_branch L_q3b
L_ps14:
  s_nop 4
  global_store_dword v2, v20, s[38:39] sc1
  s_cmp_eq_u32 s57, 0
  s_cbranch_scc1 L_pd15
  s_waitcnt vmcnt(0)
  s_branch L_pd15
.section .rodata,"a"
.p2align 6
.amdhsa_kernel interleave_layers__sliding_block_cached__mixer_token_mlp__decode_kernel
.amdhsa_next_free_vgpr 256
.amdhsa_next_free_sgpr 102
.amdhsa_accum_offset 256
.amdhsa_group_segment_fixed_size 0
.amdhsa_kernarg_size 104
.amdhsa_user_sgpr_count 2
.amdhsa_user_sgpr_kernarg_segment_ptr 1
.amdhsa_system_sgpr_workgroup_id_x 1
.end_amdhsa_kernel
```
